```python
import torch

def _softmax(x, axis=-1):
    return torch.softmax(x, dim=axis)
def _gelu(x):
    return torch.nn.functional.gelu(x, approximate="tanh")
def _silu(x):
    return torch.nn.functional.silu(x)
def _sigmoid(x):
    return torch.sigmoid(x)
def _layernorm(x, axis=-1, eps=1e-5):
    m = x.mean(dim=axis, keepdim=True)
    v = x.var(dim=axis, keepdim=True, unbiased=False)
    return (x - m) / torch.sqrt(v + eps)
def _scatter_add(tgt, idx, src, axis=0):
    return tgt.clone().index_add_(axis, idx, src)
def _segment_sum(src, seg, n):
    out = torch.zeros((n,) + src.shape[1:], dtype=src.dtype)
    return out.index_add_(0, seg, src)
def _pad(x, pw):
    flat = tuple(v for pair in reversed(pw) for v in pair)
    return torch.nn.functional.pad(x, flat)

kernel_name = 'concat_heads__gqa_block_cached__gqa_block_cached__decode'

def setup_inputs():

    _w = (lambda a: (lambda t: t.to(torch.bfloat16) if t.is_floating_point() else t)(torch.as_tensor(a)))
    def _A_setup():
        B, Sq, D = 2, 1, 576
        Hq, Hkv, Sk, Dh = 32, 16, 4096, 128
        assert Hq % Hkv == 0, (Hq, Hkv)
        return {
            "x": _w((lambda *s: torch.randn(*s, dtype=torch.bfloat16) * 0.8)(B, Sq, D)),
            "k_cache": _w((lambda *s: torch.randn(*s, dtype=torch.bfloat16) * 0.8)(B, Hkv, Sk, Dh)),
            "v_cache": _w((lambda *s: torch.randn(*s, dtype=torch.bfloat16) * 0.05)(B, Hkv, Sk, Dh)),
            "wq": _w((lambda *s: torch.randn(*s, dtype=torch.bfloat16) * 0.8)(D, Hq * Dh) * (D ** -0.5)),
            "wo": _w((lambda *s: torch.randn(*s, dtype=torch.bfloat16) * 0.05)(Hq * Dh, D) * ((Hq * Dh) ** -0.5)),
        }
    _A_in = _A_setup()

    def _B_setup():
        B, Sq, D = 2, 1, 576
        Hq, Hkv, Sk, Dh = 32, 16, 4096, 128
        assert Hq % Hkv == 0, (Hq, Hkv)
        return {
            "x": _w((lambda *s: torch.randn(*s, dtype=torch.bfloat16) * 0.8)(B, Sq, D)),
            "k_cache": _w((lambda *s: torch.randn(*s, dtype=torch.bfloat16) * 0.8)(B, Hkv, Sk, Dh)),
            "v_cache": _w((lambda *s: torch.randn(*s, dtype=torch.bfloat16) * 0.05)(B, Hkv, Sk, Dh)),
            "wq": _w((lambda *s: torch.randn(*s, dtype=torch.bfloat16) * 0.8)(D, Hq * Dh) * (D ** -0.5)),
            "wo": _w((lambda *s: torch.randn(*s, dtype=torch.bfloat16) * 0.05)(Hq * Dh, D) * ((Hq * Dh) ** -0.5)),
        }
    _B_in = _B_setup()

    return {
        "A_x": _A_in["x"],
        "A_k_cache": _A_in["k_cache"],
        "A_v_cache": _A_in["v_cache"],
        "A_wq": _A_in["wq"],
        "A_wo": _A_in["wo"],
        "B_x": _B_in["x"],
        "B_k_cache": _B_in["k_cache"],
        "B_v_cache": _B_in["v_cache"],
        "B_wq": _B_in["wq"],
        "B_wo": _B_in["wo"],
    }

def reference(A_x, A_k_cache, A_v_cache, A_wq, A_wo, B_x, B_k_cache, B_v_cache, B_wq, B_wo):
    def _A_ref(x, k_cache, v_cache, wq, wo):
        B, Sq, D = x.shape
        Hq, Dh = 32, 128
        Hkv = k_cache.shape[1]
        rep = Hq // Hkv
        q = (lambda x, *d: x.permute(*d))((x @ wq).reshape(B, Sq, Hq, Dh), 0, 2, 1, 3)
        k = (lambda x, n, axis: torch.repeat_interleave(x, n, dim=axis))(k_cache, rep, axis=1)
        v = (lambda x, n, axis: torch.repeat_interleave(x, n, dim=axis))(v_cache, rep, axis=1)
        scores = torch.einsum("bhqd,bhkd->bhqk", q, k) * (Dh ** -0.5)
        p = _softmax(scores, axis=-1)
        o = torch.einsum("bhqk,bhkd->bhqd", p, v)
        return (lambda x, *d: x.permute(*d))(o, 0, 2, 1, 3).reshape(B, Sq, Hq * Dh) @ wo

    def _B_ref(x, k_cache, v_cache, wq, wo):
        B, Sq, D = x.shape
        Hq, Dh = 32, 128
        Hkv = k_cache.shape[1]
        rep = Hq // Hkv
        q = (lambda x, *d: x.permute(*d))((x @ wq).reshape(B, Sq, Hq, Dh), 0, 2, 1, 3)
        k = (lambda x, n, axis: torch.repeat_interleave(x, n, dim=axis))(k_cache, rep, axis=1)
        v = (lambda x, n, axis: torch.repeat_interleave(x, n, dim=axis))(v_cache, rep, axis=1)
        scores = torch.einsum("bhqd,bhkd->bhqk", q, k) * (Dh ** -0.5)
        p = _softmax(scores, axis=-1)
        o = torch.einsum("bhqk,bhkd->bhqd", p, v)
        return (lambda x, *d: x.permute(*d))(o, 0, 2, 1, 3).reshape(B, Sq, Hq * Dh) @ wo

    a = _A_ref(A_x, A_k_cache, A_v_cache, A_wq, A_wo)
    b = _B_ref(B_x, B_k_cache, B_v_cache, B_wq, B_wo)
    return torch.concatenate([a, b], axis=-1)
```

```asm
; @launch grid=(256,1,1) block=(512,1,1) lds=112640
.amdgcn_target "amdgcn-amd-amdhsa--gfx950"
.text
.globl concat_heads__gqa_block_cached__gqa_block_cached__decode_kernel
.p2align 8
.type concat_heads__gqa_block_cached__gqa_block_cached__decode_kernel,@function
concat_heads__gqa_block_cached__gqa_block_cached__decode_kernel:
    s_cmp_ge_u32 s2, 256
    s_cbranch_scc1 L_end
    s_and_b32 s37, s2, 1
    s_mul_i32 s3, s37, 40
    s_load_dwordx2 s[8:9], s[0:1], s3 offset:8
    s_load_dwordx2 s[20:21], s[0:1], s3 offset:24
    s_load_dwordx2 s[24:25], s[0:1], s3 offset:0
    v_lshrrev_b32 v3, 6, v0
    s_mov_b32 s48, s3
    v_readfirstlane_b32 s36, v3
    v_and_b32 v7, 63, v0
    s_bfe_u32 s38, s2, 0x20001
    s_lshl_b32 s38, s38, 2
    s_lshr_b32 s3, s2, 6
    s_or_b32 s38, s38, s3
    s_bfe_u32 s39, s2, 0x30003
    v_lshlrev_b32 v2, 4, v7
    v_lshrrev_b32 v5, 4, v7
    s_cmp_ge_u32 s36, 2
    s_cbranch_scc0 L_c0
    s_sub_u32 s3, s36, 2
    s_bfe_u32 s5, s3, 0x10002
    s_and_b32 s3, s3, 3
    s_lshl_b32 s41, s3, 12
    s_lshl_b32 s3, s5, 14
    s_or_b32 s41, s41, s3
    s_lshl_b32 s3, s38, 20
    s_or_b32 s41, s41, s3
    s_and_b32 s3, s39, 3
    s_lshl_b32 s3, s3, 18
    s_or_b32 s41, s41, s3
    s_lshr_b32 s3, s39, 2
    s_lshl_b32 s3, s3, 24
    s_or_b32 s41, s41, s3
    s_mov_b32 s10, 0x2000000
    s_mov_b32 s11, 0x20000
    v_and_b32 v3, 3, v7
    v_bfe_u32 v4, v7, 2, 2
    v_lshlrev_b32 v1, 6, v5
    v_lshl_add_u32 v1, v3, 4, v1
    v_lshl_add_u32 v1, v4, 8, v1
    s_cmp_eq_u32 s5, 1
    s_cbranch_scc1 L_late0
    s_waitcnt lgkmcnt(0)
    s_xor_b32 s42, s41, 0
    buffer_load_dwordx4 v[128:131], v1, s[8:11], s42 offen offset:0 nt
    buffer_load_dwordx4 v[132:135], v1, s[8:11], s42 offen offset:1024 nt
    buffer_load_dwordx4 v[136:139], v1, s[8:11], s42 offen offset:2048 nt
    s_branch L_s1
L_c0:
    s_mov_b32 s26, 0x900
    s_mov_b32 s27, 0x20000
    s_mov_b32 s22, 0x480000
    s_mov_b32 s23, 0x20000
    s_mul_i32 s49, s36, 2560
    s_add_u32 m0, s49, 9216
    v_and_b32 v4, 0xf0, v2
    v_lshl_add_u32 v30, v5, 13, v4
    s_mul_i32 s42, s39, 64
    s_or_b32 s42, s42, s38
    s_lshl_b32 s42, s42, 1
    s_or_b32 s42, s42, s36
    s_lshl_b32 s42, s42, 8
    s_mov_b32 s3, 262144
    s_waitcnt lgkmcnt(0)
    buffer_load_dwordx4 v[128:131], v30, s[20:23], s42 offen nt
    s_add_u32 s42, s42, s3
    buffer_load_dwordx4 v[132:135], v30, s[20:23], s42 offen nt
    s_add_u32 s42, s42, s3
    buffer_load_dwordx4 v[136:139], v30, s[20:23], s42 offen nt
    s_add_u32 s42, s42, s3
    buffer_load_dwordx4 v[140:143], v30, s[20:23], s42 offen nt
    s_add_u32 s42, s42, s3
    buffer_load_dwordx4 v[144:147], v30, s[20:23], s42 offen nt
    s_add_u32 s42, s42, s3
    buffer_load_dwordx4 v[148:151], v30, s[20:23], s42 offen nt
    s_add_u32 s42, s42, s3
    buffer_load_dwordx4 v[152:155], v30, s[20:23], s42 offen nt
    s_add_u32 s42, s42, s3
    buffer_load_dwordx4 v[156:159], v30, s[20:23], s42 offen nt
    s_add_u32 s42, s42, s3
    buffer_load_dwordx4 v[160:163], v30, s[20:23], s42 offen nt
    s_add_u32 s42, s42, s3
    buffer_load_dwordx4 v[164:167], v30, s[20:23], s42 offen nt
    s_add_u32 s42, s42, s3
    buffer_load_dwordx4 v[168:171], v30, s[20:23], s42 offen nt
    s_add_u32 s42, s42, s3
    buffer_load_dwordx4 v[172:175], v30, s[20:23], s42 offen nt
    s_add_u32 s42, s42, s3
    buffer_load_dwordx4 v[176:179], v30, s[20:23], s42 offen nt
    s_add_u32 s42, s42, s3
    buffer_load_dwordx4 v[180:183], v30, s[20:23], s42 offen nt
    s_add_u32 s42, s42, s3
    buffer_load_dwordx4 v[184:187], v30, s[20:23], s42 offen nt
    s_add_u32 s42, s42, s3
    buffer_load_dwordx4 v[188:191], v30, s[20:23], s42 offen nt
    s_add_u32 s42, s42, s3
    buffer_load_dwordx4 v[192:195], v30, s[20:23], s42 offen nt
    s_add_u32 s42, s42, s3
    buffer_load_dwordx4 v[196:199], v30, s[20:23], s42 offen nt
    buffer_load_dwordx4 v2, s[24:27], 0 offen lds
    buffer_load_dwordx4 v2, s[24:27], 0 offen offset:1024 lds
    s_mov_b32 exec_hi, 0
    buffer_load_dwordx4 v2, s[24:27], 0 offen offset:2048 lds
    s_mov_b32 exec_hi, -1
    s_barrier
    s_branch L_comm
L_s1:
    s_barrier
    buffer_load_dwordx4 v[140:143], v1, s[8:11], s42 offen offset:3072 nt
    s_xor_b32 s42, s41, 65536
    buffer_load_dwordx4 v[144:147], v1, s[8:11], s42 offen offset:0 nt
    buffer_load_dwordx4 v[148:151], v1, s[8:11], s42 offen offset:1024 nt
    s_load_dwordx2 s[28:29], s[0:1], 96
    s_load_dwordx2 s[12:13], s[0:1], s48 offset:16
    s_load_dwordx2 s[16:17], s[0:1], s48 offset:32
    s_load_dwordx2 s[32:33], s[0:1], 80
    s_mov_b32 s14, 0x2000000
    s_mov_b32 s15, 0x20000
    s_mov_b32 s30, 0x200000
    s_mov_b32 s31, 0x20000
    s_mov_b32 s18, 0x480000
    s_mov_b32 s19, 0x20000
    s_mov_b32 s34, 0x1200
    s_mov_b32 s35, 0x20000
    s_lshl_b32 s40, s37, 4
    s_add_u32 s40, s40, s38
    s_lshl_b32 s3, s37, 8
    s_waitcnt lgkmcnt(0)
    s_load_dword s43, s[28:29], s3
    s_load_dword s96, s[28:29], 0
    v_mov_b32 v0, 0
    v_and_b32 v3, 1, v7
    v_lshlrev_b32 v3, 4, v3
    v_mov_b32 v4, 0xffff
    v_lshlrev_b32 v3, v3, v4
    v_bfe_u32 v4, v7, 1, 2
    v_cmp_eq_u32 s[52:53], 0, v4
    v_cmp_eq_u32 s[54:55], 1, v4
    v_cmp_eq_u32 s[56:57], 2, v4
    v_cmp_eq_u32 s[58:59], 3, v4
    s_nop 1
    v_cndmask_b32 v12, 0, v3, s[52:53]
    v_cndmask_b32 v13, 0, v3, s[54:55]
    v_cndmask_b32 v14, 0, v3, s[56:57]
    v_cndmask_b32 v15, 0, v3, s[58:59]
    s_branch L_kcont
L_late0:
    v_mov_b32 v16, 0
    v_mov_b32 v17, 0
    v_mov_b32 v18, 0
    v_mov_b32 v19, 0
    s_memrealtime s[98:99]
    s_mov_b64 exec, 63
    ds_write_b128 v2, v[16:19] offset:768
    s_mov_b64 exec, 3
    s_waitcnt lgkmcnt(0)
    s_add_u32 s3, s98, 70
    v_writelane_b32 v17, s3, 1
    ds_write_b128 v2, v[16:19] offset:512
    s_mov_b64 exec, -1
    s_waitcnt lgkmcnt(0)
    s_barrier
    s_branch L_late1
L_kgo:
    s_xor_b32 s42, s41, 0
    buffer_load_dwordx4 v[128:131], v1, s[8:11], s42 offen offset:0 nt
    buffer_load_dwordx4 v[132:135], v1, s[8:11], s42 offen offset:1024 nt
    buffer_load_dwordx4 v[136:139], v1, s[8:11], s42 offen offset:2048 nt
    buffer_load_dwordx4 v[140:143], v1, s[8:11], s42 offen offset:3072 nt
    s_xor_b32 s42, s41, 65536
    buffer_load_dwordx4 v[144:147], v1, s[8:11], s42 offen offset:0 nt
    buffer_load_dwordx4 v[148:151], v1, s[8:11], s42 offen offset:1024 nt
L_kcont:
    s_mov_b64 vcc, 0
    s_lshl_b32 s3, s5, 4
    s_add_u32 s3, s3, 1
    s_mul_i32 s100, s3, 58
    s_lshl_b32 s3, s5, 5
    v_mov_b32 v23, s3
    s_and_b32 s3, s36, 3
    s_cmp_eq_u32 s3, 2
    s_cselect_b64 s[62:63], 1, 0
    s_memrealtime s[98:99]
    ds_read_b32 v31, v0 offset:532
    s_mul_i32 s48, s36, 12288
    s_add_u32 s48, s48, 14336
    s_mov_b32 s46, 0x3e0293ee
    v_lshrrev_b32 v5, 4, v7
    v_bfe_u32 v6, v7, 3, 1
    v_lshlrev_b32 v6, 8, v6
    v_lshl_add_u32 v6, v5, 6, v6
    v_and_b32 v4, 3, v7
    v_lshl_add_u32 v6, v4, 4, v6
    v_add_u32 v30, s48, v2
    s_waitcnt vmcnt(6)
    s_cbranch_vccz L_t1
    s_waitcnt vmcnt(4)
L_t1:
    buffer_load_dwordx4 v[152:155], v1, s[8:11], s42 offen offset:2048 nt
    s_waitcnt vmcnt(6)
    s_cbranch_vccz L_t2
    s_waitcnt vmcnt(4)
L_t2:
    buffer_load_dwordx4 v[156:159], v1, s[8:11], s42 offen offset:3072 nt
    s_waitcnt lgkmcnt(0)
    v_readfirstlane_b32 s101, v31
    s_sub_u32 s98, s98, s100
    s_sub_u32 s3, s98, s101
    s_cmp_lt_i32 s3, 0
    s_cselect_b64 vcc, -1, 0
    s_add_u32 s100, s100, 58
    s_memrealtime s[98:99]
    ds_read_b32 v31, v0 offset:532
    s_waitcnt vmcnt(6)
    s_cbranch_vccz L_t3
    s_waitcnt vmcnt(4)
L_t3:
    s_xor_b32 s42, s41, 32768
    buffer_load_dwordx4 v[160:163], v1, s[8:11], s42 offen offset:0 nt
    s_waitcnt vmcnt(6)
    s_cbranch_vccz L_t4
    s_waitcnt vmcnt(4)
L_t4:
    buffer_load_dwordx4 v[164:167], v1, s[8:11], s42 offen offset:1024 nt
    s_waitcnt vmcnt(6)
    s_cbranch_vccz L_t5
    s_waitcnt vmcnt(4)
L_t5:
    buffer_load_dwordx4 v[168:171], v1, s[8:11], s42 offen offset:2048 nt
    s_waitcnt vmcnt(6)
    s_cbranch_vccz L_t6
    s_waitcnt vmcnt(4)
L_t6:
    buffer_load_dwordx4 v[172:175], v1, s[8:11], s42 offen offset:3072 nt
    s_waitcnt lgkmcnt(0)
    v_readfirstlane_b32 s101, v31
    s_sub_u32 s98, s98, s100
    s_sub_u32 s3, s98, s101
    s_cmp_lt_i32 s3, 0
    s_cselect_b64 vcc, -1, 0
    s_add_u32 s100, s100, 58
    s_or_b32 s3, s98, 1
    v_mov_b32 v22, s3
    s_mov_b64 exec, s[62:63]
    ds_write_b32 v23, v22 offset:772
    s_mov_b64 exec, -1
    s_memrealtime s[98:99]
    ds_read_b32 v31, v0 offset:532
    s_waitcnt vmcnt(6)
    s_cbranch_vccz L_t7
    s_waitcnt vmcnt(4)
L_t7:
    s_xor_b32 s42, s41, 98304
    buffer_load_dwordx4 v[176:179], v1, s[8:11], s42 offen offset:0 nt
    s_waitcnt vmcnt(6)
    s_cbranch_vccz L_t8
    s_waitcnt vmcnt(4)
L_t8:
    buffer_load_dwordx4 v[180:183], v1, s[8:11], s42 offen offset:1024 nt
    s_waitcnt vmcnt(6)
    s_cbranch_vccz L_t9
    s_waitcnt vmcnt(4)
L_t9:
    buffer_load_dwordx4 v[184:187], v1, s[8:11], s42 offen offset:2048 nt
    s_waitcnt vmcnt(6)
    s_cbranch_vccz L_t10
    s_waitcnt vmcnt(4)
L_t10:
    buffer_load_dwordx4 v[188:191], v1, s[8:11], s42 offen offset:3072 nt
    s_waitcnt lgkmcnt(0)
    v_readfirstlane_b32 s101, v31
    s_sub_u32 s98, s98, s100
    s_sub_u32 s3, s98, s101
    s_cmp_lt_i32 s3, 0
    s_cselect_b64 vcc, -1, 0
    s_add_u32 s100, s100, 58
    s_memrealtime s[98:99]
    ds_read_b32 v31, v0 offset:532
    s_waitcnt vmcnt(6)
    s_cbranch_vccz L_t11
    s_waitcnt vmcnt(4)
L_t11:
    s_xor_b32 s42, s41, 131072
    buffer_load_dwordx4 v[192:195], v1, s[8:11], s42 offen offset:0 nt
    s_waitcnt vmcnt(6)
    s_cbranch_vccz L_t12
    s_waitcnt vmcnt(4)
L_t12:
    buffer_load_dwordx4 v[196:199], v1, s[8:11], s42 offen offset:1024 nt
    s_waitcnt vmcnt(6)
    s_cbranch_vccz L_t13
    s_waitcnt vmcnt(4)
L_t13:
    buffer_load_dwordx4 v[200:203], v1, s[8:11], s42 offen offset:2048 nt
    s_waitcnt vmcnt(6)
    s_cbranch_vccz L_t14
    s_waitcnt vmcnt(4)
L_t14:
    buffer_load_dwordx4 v[204:207], v1, s[8:11], s42 offen offset:3072 nt
    s_waitcnt lgkmcnt(0)
    v_readfirstlane_b32 s101, v31
    s_sub_u32 s98, s98, s100
    s_sub_u32 s3, s98, s101
    s_cmp_lt_i32 s3, 0
    s_cselect_b64 vcc, -1, 0
    s_add_u32 s100, s100, 58
    s_or_b32 s3, s98, 1
    v_mov_b32 v22, s3
    s_mov_b64 exec, s[62:63]
    ds_write_b32 v23, v22 offset:776
    s_mov_b64 exec, -1
    s_memrealtime s[98:99]
    ds_read_b32 v31, v0 offset:532
    s_waitcnt vmcnt(6)
    s_cbranch_vccz L_t15
    s_waitcnt vmcnt(4)
L_t15:
    s_xor_b32 s42, s41, 196608
    buffer_load_dwordx4 v[208:211], v1, s[8:11], s42 offen offset:0 nt
    s_waitcnt vmcnt(6)
    s_cbranch_vccz L_t16
    s_waitcnt vmcnt(4)
L_t16:
    buffer_load_dwordx4 v[212:215], v1, s[8:11], s42 offen offset:1024 nt
    s_waitcnt vmcnt(6)
    s_cbranch_vccz L_t17
    s_waitcnt vmcnt(4)
L_t17:
    buffer_load_dwordx4 v[216:219], v1, s[8:11], s42 offen offset:2048 nt
    s_waitcnt vmcnt(6)
    s_cbranch_vccz L_t18
    s_waitcnt vmcnt(4)
L_t18:
    buffer_load_dwordx4 v[220:223], v1, s[8:11], s42 offen offset:3072 nt
    s_waitcnt lgkmcnt(0)
    v_readfirstlane_b32 s101, v31
    s_sub_u32 s98, s98, s100
    s_sub_u32 s3, s98, s101
    s_cmp_lt_i32 s3, 0
    s_cselect_b64 vcc, -1, 0
    s_add_u32 s100, s100, 58
    s_memrealtime s[98:99]
    ds_read_b32 v31, v0 offset:532
    s_waitcnt vmcnt(6)
    s_cbranch_vccz L_t19
    s_waitcnt vmcnt(4)
L_t19:
    s_xor_b32 s42, s41, 163840
    buffer_load_dwordx4 v[224:227], v1, s[8:11], s42 offen offset:0 nt
    s_waitcnt vmcnt(6)
    s_cbranch_vccz L_t20
    s_waitcnt vmcnt(4)
L_t20:
    buffer_load_dwordx4 v[228:231], v1, s[8:11], s42 offen offset:1024 nt
    s_waitcnt vmcnt(6)
    s_cbranch_vccz L_t21
    s_waitcnt vmcnt(4)
L_t21:
    buffer_load_dwordx4 v[232:235], v1, s[8:11], s42 offen offset:2048 nt
    s_waitcnt vmcnt(6)
    s_cbranch_vccz L_t22
    s_waitcnt vmcnt(4)
L_t22:
    buffer_load_dwordx4 v[236:239], v1, s[8:11], s42 offen offset:3072 nt
    s_waitcnt lgkmcnt(0)
    v_readfirstlane_b32 s101, v31
    s_sub_u32 s98, s98, s100
    s_sub_u32 s3, s98, s101
    s_cmp_lt_i32 s3, 0
    s_cselect_b64 vcc, -1, 0
    s_add_u32 s100, s100, 58
    s_or_b32 s3, s98, 1
    v_mov_b32 v22, s3
    s_mov_b64 exec, s[62:63]
    ds_write_b32 v23, v22 offset:780
    s_mov_b64 exec, -1
    s_memrealtime s[98:99]
    ds_read_b32 v31, v0 offset:532
    s_waitcnt vmcnt(6)
    s_cbranch_vccz L_t23
    s_waitcnt vmcnt(4)
L_t23:
    s_xor_b32 s42, s41, 229376
    buffer_load_dwordx4 v[240:243], v1, s[8:11], s42 offen offset:0 nt
    s_waitcnt vmcnt(6)
    s_cbranch_vccz L_t24
    s_waitcnt vmcnt(4)
L_t24:
    buffer_load_dwordx4 v[244:247], v1, s[8:11], s42 offen offset:1024 nt
    s_waitcnt vmcnt(6)
    s_cbranch_vccz L_t25
    s_waitcnt vmcnt(4)
L_t25:
    buffer_load_dwordx4 v[248:251], v1, s[8:11], s42 offen offset:2048 nt
    s_waitcnt vmcnt(6)
    s_cbranch_vccz L_t26
    s_waitcnt vmcnt(4)
L_t26:
    buffer_load_dwordx4 v[252:255], v1, s[8:11], s42 offen offset:3072 nt
    s_cmp_eq_u32 s5, 1
    s_cbranch_scc1 L_lateV
    s_waitcnt lgkmcnt(0)
    v_readfirstlane_b32 s101, v31
    s_sub_u32 s98, s98, s100
    s_sub_u32 s3, s98, s101
    s_cmp_lt_i32 s3, 0
    s_cselect_b64 vcc, -1, 0
    s_add_u32 s100, s100, 58
    s_memrealtime s[98:99]
    ds_read_b32 v31, v0 offset:532
    s_waitcnt vmcnt(6)
    s_cbranch_vccz L_t27
    s_waitcnt vmcnt(4)
L_t27:
    s_xor_b32 s42, s41, 0
    s_add_u32 m0, s48, 0
    s_nop 0
    buffer_load_dwordx4 v2, s[12:15], s42 offen offset:0 nt lds
    s_waitcnt vmcnt(6)
    s_cbranch_vccz L_t28
    s_waitcnt vmcnt(4)
L_t28:
    buffer_load_dwordx4 v2, s[12:15], s42 offen offset:1024 nt lds
    s_waitcnt vmcnt(6)
    s_cbranch_vccz L_t29
    s_waitcnt vmcnt(4)
L_t29:
    buffer_load_dwordx4 v2, s[12:15], s42 offen offset:2048 nt lds
    s_waitcnt vmcnt(6)
    s_cbranch_vccz L_t30
    s_waitcnt vmcnt(4)
L_t30:
    buffer_load_dwordx4 v2, s[12:15], s42 offen offset:3072 nt lds
    s_waitcnt lgkmcnt(0)
    v_readfirstlane_b32 s101, v31
    s_sub_u32 s98, s98, s100
    s_sub_u32 s3, s98, s101
    s_cmp_lt_i32 s3, 0
    s_cselect_b64 vcc, -1, 0
    s_add_u32 s100, s100, 58
    s_or_b32 s3, s98, 1
    v_mov_b32 v22, s3
    s_mov_b64 exec, s[62:63]
    ds_write_b32 v23, v22 offset:784
    s_mov_b64 exec, -1
    s_memrealtime s[98:99]
    ds_read_b32 v31, v0 offset:532
    s_waitcnt vmcnt(6)
    s_cbranch_vccz L_t31
    s_waitcnt vmcnt(4)
L_t31:
    s_xor_b32 s42, s41, 65536
    s_add_u32 m0, s48, 4096
    s_nop 0
    buffer_load_dwordx4 v2, s[12:15], s42 offen offset:0 nt lds
    s_waitcnt vmcnt(6)
    s_cbranch_vccz L_t32
    s_waitcnt vmcnt(4)
L_t32:
    buffer_load_dwordx4 v2, s[12:15], s42 offen offset:1024 nt lds
    s_waitcnt vmcnt(6)
    s_cbranch_vccz L_t33
    s_waitcnt vmcnt(4)
L_t33:
    buffer_load_dwordx4 v2, s[12:15], s42 offen offset:2048 nt lds
    s_waitcnt vmcnt(6)
    s_cbranch_vccz L_t34
    s_waitcnt vmcnt(4)
L_t34:
    buffer_load_dwordx4 v2, s[12:15], s42 offen offset:3072 nt lds
    s_waitcnt lgkmcnt(0)
    v_readfirstlane_b32 s101, v31
    s_sub_u32 s98, s98, s100
    s_sub_u32 s3, s98, s101
    s_cmp_lt_i32 s3, 0
    s_cselect_b64 vcc, -1, 0
    s_add_u32 s100, s100, 58
    s_memrealtime s[98:99]
    ds_read_b32 v31, v0 offset:532
    s_waitcnt vmcnt(6)
    s_cbranch_vccz L_t35
    s_waitcnt vmcnt(4)
L_t35:
    s_xor_b32 s42, s41, 32768
    s_add_u32 m0, s48, 8192
    s_nop 0
    buffer_load_dwordx4 v2, s[12:15], s42 offen offset:0 nt lds
    s_waitcnt vmcnt(6)
    s_cbranch_vccz L_t36
    s_waitcnt vmcnt(4)
L_t36:
    buffer_load_dwordx4 v2, s[12:15], s42 offen offset:1024 nt lds
    s_waitcnt vmcnt(6)
    s_cbranch_vccz L_t37
    s_waitcnt vmcnt(4)
L_t37:
    buffer_load_dwordx4 v2, s[12:15], s42 offen offset:2048 nt lds
    s_waitcnt vmcnt(6)
    s_cbranch_vccz L_t38
    s_waitcnt vmcnt(4)
L_t38:
    buffer_load_dwordx4 v2, s[12:15], s42 offen offset:3072 nt lds
    s_waitcnt lgkmcnt(0)
    v_readfirstlane_b32 s101, v31
    s_sub_u32 s98, s98, s100
    s_sub_u32 s3, s98, s101
    s_cmp_lt_i32 s3, 0
    s_cselect_b64 vcc, -1, 0
    s_add_u32 s100, s100, 58
    s_or_b32 s3, s98, 1
    v_mov_b32 v22, s3
    s_mov_b64 exec, s[62:63]
    ds_write_b32 v23, v22 offset:788
    s_mov_b64 exec, -1
    s_memrealtime s[98:99]
    ds_read_b32 v31, v0 offset:532
    s_waitcnt vmcnt(6)
    s_cbranch_vccz L_t39
    s_waitcnt vmcnt(4)
L_t39:
    s_xor_b32 s42, s41, 98304
    buffer_load_dwordx4 v[48:51], v2, s[12:15], s42 offen offset:0 nt
    s_waitcnt vmcnt(6)
    s_cbranch_vccz L_t40
    s_waitcnt vmcnt(4)
L_t40:
    buffer_load_dwordx4 v[52:55], v2, s[12:15], s42 offen offset:1024 nt
    s_waitcnt vmcnt(6)
    s_cbranch_vccz L_t41
    s_waitcnt vmcnt(4)
L_t41:
    buffer_load_dwordx4 v[56:59], v2, s[12:15], s42 offen offset:2048 nt
    s_waitcnt vmcnt(6)
    s_cbranch_vccz L_t42
    s_waitcnt vmcnt(4)
L_t42:
    buffer_load_dwordx4 v[60:63], v2, s[12:15], s42 offen offset:3072 nt
    s_waitcnt lgkmcnt(0)
    v_readfirstlane_b32 s101, v31
    s_sub_u32 s98, s98, s100
    s_sub_u32 s3, s98, s101
    s_cmp_lt_i32 s3, 0
    s_cselect_b64 vcc, -1, 0
    s_add_u32 s100, s100, 58
    s_memrealtime s[98:99]
    ds_read_b32 v31, v0 offset:532
    s_waitcnt vmcnt(6)
    s_cbranch_vccz L_t43
    s_waitcnt vmcnt(4)
L_t43:
    s_xor_b32 s42, s41, 131072
    buffer_load_dwordx4 v[64:67], v2, s[12:15], s42 offen offset:0 nt
    s_waitcnt vmcnt(6)
    s_cbranch_vccz L_t44
    s_waitcnt vmcnt(4)
L_t44:
    buffer_load_dwordx4 v[68:71], v2, s[12:15], s42 offen offset:1024 nt
    s_waitcnt vmcnt(6)
    s_cbranch_vccz L_t45
    s_waitcnt vmcnt(4)
L_t45:
    buffer_load_dwordx4 v[72:75], v2, s[12:15], s42 offen offset:2048 nt
    s_waitcnt vmcnt(6)
    s_cbranch_vccz L_t46
    s_waitcnt vmcnt(4)
L_t46:
    buffer_load_dwordx4 v[76:79], v2, s[12:15], s42 offen offset:3072 nt
    s_waitcnt lgkmcnt(0)
    v_readfirstlane_b32 s101, v31
    s_sub_u32 s98, s98, s100
    s_sub_u32 s3, s98, s101
    s_cmp_lt_i32 s3, 0
    s_cselect_b64 vcc, -1, 0
    s_add_u32 s100, s100, 58
    s_or_b32 s3, s98, 1
    v_mov_b32 v22, s3
    s_mov_b64 exec, s[62:63]
    ds_write_b32 v23, v22 offset:792
    s_mov_b64 exec, -1
    s_memrealtime s[98:99]
    ds_read_b32 v31, v0 offset:532
    s_waitcnt vmcnt(6)
    s_cbranch_vccz L_t47
    s_waitcnt vmcnt(4)
L_t47:
    s_xor_b32 s42, s41, 196608
    buffer_load_dwordx4 v[80:83], v2, s[12:15], s42 offen offset:0 nt
    s_waitcnt vmcnt(6)
    s_cbranch_vccz L_t48
    s_waitcnt vmcnt(4)
L_t48:
    buffer_load_dwordx4 v[84:87], v2, s[12:15], s42 offen offset:1024 nt
    s_waitcnt vmcnt(6)
    s_cbranch_vccz L_t49
    s_waitcnt vmcnt(4)
L_t49:
    buffer_load_dwordx4 v[88:91], v2, s[12:15], s42 offen offset:2048 nt
    s_waitcnt vmcnt(6)
    s_cbranch_vccz L_t50
    s_waitcnt vmcnt(4)
L_t50:
    buffer_load_dwordx4 v[92:95], v2, s[12:15], s42 offen offset:3072 nt
    s_waitcnt lgkmcnt(0)
    v_readfirstlane_b32 s101, v31
    s_sub_u32 s98, s98, s100
    s_sub_u32 s3, s98, s101
    s_cmp_lt_i32 s3, 0
    s_cselect_b64 vcc, -1, 0
    s_add_u32 s100, s100, 58
    s_memrealtime s[98:99]
    ds_read_b32 v31, v0 offset:532
    s_waitcnt vmcnt(6)
    s_cbranch_vccz L_t51
    s_waitcnt vmcnt(4)
L_t51:
    s_xor_b32 s42, s41, 163840
    buffer_load_dwordx4 v[96:99], v2, s[12:15], s42 offen offset:0 nt
    s_waitcnt vmcnt(6)
    s_cbranch_vccz L_t52
    s_waitcnt vmcnt(4)
L_t52:
    buffer_load_dwordx4 v[100:103], v2, s[12:15], s42 offen offset:1024 nt
    s_waitcnt vmcnt(6)
    s_cbranch_vccz L_t53
    s_waitcnt vmcnt(4)
L_t53:
    buffer_load_dwordx4 v[104:107], v2, s[12:15], s42 offen offset:2048 nt
    s_waitcnt vmcnt(6)
    s_cbranch_vccz L_t54
    s_waitcnt vmcnt(4)
L_t54:
    buffer_load_dwordx4 v[108:111], v2, s[12:15], s42 offen offset:3072 nt
    s_waitcnt lgkmcnt(0)
    v_readfirstlane_b32 s101, v31
    s_sub_u32 s98, s98, s100
    s_sub_u32 s3, s98, s101
    s_cmp_lt_i32 s3, 0
    s_cselect_b64 vcc, -1, 0
    s_add_u32 s100, s100, 58
    s_or_b32 s3, s98, 1
    v_mov_b32 v22, s3
    s_mov_b64 exec, s[62:63]
    ds_write_b32 v23, v22 offset:796
    s_mov_b64 exec, -1
    s_memrealtime s[98:99]
    ds_read_b32 v31, v0 offset:532
    s_waitcnt vmcnt(6)
    s_cbranch_vccz L_t55
    s_waitcnt vmcnt(4)
L_t55:
    s_xor_b32 s42, s41, 229376
    buffer_load_dwordx4 v[112:115], v2, s[12:15], s42 offen offset:0 nt
    s_waitcnt vmcnt(6)
    s_cbranch_vccz L_t56
    s_waitcnt vmcnt(4)
L_t56:
    buffer_load_dwordx4 v[116:119], v2, s[12:15], s42 offen offset:1024 nt
    s_waitcnt vmcnt(6)
    s_cbranch_vccz L_t57
    s_waitcnt vmcnt(4)
L_t57:
    buffer_load_dwordx4 v[120:123], v2, s[12:15], s42 offen offset:2048 nt
    s_waitcnt vmcnt(6)
    s_cbranch_vccz L_t58
    s_waitcnt vmcnt(4)
L_t58:
    buffer_load_dwordx4 v[124:127], v2, s[12:15], s42 offen offset:3072 nt
    s_mov_b64 exec, 1
    v_mov_b32 v3, 1
    ds_add_u32 v0, v3 offset:516
    s_mov_b64 exec, -1
    s_mov_b32 s47, 8388608
L_wQ:
    ds_read_b32 v3, v0 offset:512
    s_waitcnt lgkmcnt(0)
    v_readfirstlane_b32 s3, v3
    s_cmp_ge_u32 s3, 2
    s_cbranch_scc1 L_gQ
    s_sub_u32 s47, s47, 1
    s_cbranch_scc1 L_end
    s_sleep 4
    s_branch L_wQ
L_gQ:
    ds_read_b128 v[8:11], v6 offset:0
    s_waitcnt lgkmcnt(0)
    s_add_u32 s44, s43, 0x9e3779b9
    s_waitcnt vmcnt(60)
    v_mfma_f32_16x16x32_bf16 v[128:131], v[128:131], v[8:11], 0
    v_mfma_f32_16x16x32_bf16 v[132:135], v[132:135], v[8:11], 0
    v_mfma_f32_16x16x32_bf16 v[136:139], v[136:139], v[8:11], 0
    v_mfma_f32_16x16x32_bf16 v[140:143], v[140:143], v[8:11], 0
    s_waitcnt vmcnt(56)
    v_mfma_f32_16x16x32_bf16 v[144:147], v[144:147], v[8:11], 0
    v_mfma_f32_16x16x32_bf16 v[148:151], v[148:151], v[8:11], 0
    v_mfma_f32_16x16x32_bf16 v[152:155], v[152:155], v[8:11], 0
    v_mfma_f32_16x16x32_bf16 v[156:159], v[156:159], v[8:11], 0
    s_nop 3
    v_mov_b32_dpp v32, v128 quad_perm:[0,0,0,0] row_mask:0xf bank_mask:0x5
    v_mov_b32_dpp v33, v132 quad_perm:[0,0,0,0] row_mask:0xf bank_mask:0x5
    v_mov_b32_dpp v34, v136 quad_perm:[0,0,0,0] row_mask:0xf bank_mask:0x5
    v_mov_b32_dpp v35, v140 quad_perm:[0,0,0,0] row_mask:0xf bank_mask:0x5
    v_add_f32_dpp v32, v129, v32 quad_perm:[1,1,1,1] row_mask:0xf bank_mask:0x5
    v_add_f32_dpp v33, v133, v33 quad_perm:[1,1,1,1] row_mask:0xf bank_mask:0x5
    v_add_f32_dpp v34, v137, v34 quad_perm:[1,1,1,1] row_mask:0xf bank_mask:0x5
    v_add_f32_dpp v35, v141, v35 quad_perm:[1,1,1,1] row_mask:0xf bank_mask:0x5
    v_add_f32_dpp v32, v130, v32 quad_perm:[2,2,2,2] row_mask:0xf bank_mask:0x5
    v_add_f32_dpp v33, v134, v33 quad_perm:[2,2,2,2] row_mask:0xf bank_mask:0x5
    v_add_f32_dpp v34, v138, v34 quad_perm:[2,2,2,2] row_mask:0xf bank_mask:0x5
    v_add_f32_dpp v35, v142, v35 quad_perm:[2,2,2,2] row_mask:0xf bank_mask:0x5
    v_add_f32_dpp v32, v131, v32 quad_perm:[3,3,3,3] row_mask:0xf bank_mask:0x5
    v_add_f32_dpp v33, v135, v33 quad_perm:[3,3,3,3] row_mask:0xf bank_mask:0x5
    v_add_f32_dpp v34, v139, v34 quad_perm:[3,3,3,3] row_mask:0xf bank_mask:0x5
    v_add_f32_dpp v35, v143, v35 quad_perm:[3,3,3,3] row_mask:0xf bank_mask:0x5
    s_waitcnt vmcnt(52)
    v_mfma_f32_16x16x32_bf16 v[160:163], v[160:163], v[8:11], 0
    v_mfma_f32_16x16x32_bf16 v[164:167], v[164:167], v[8:11], 0
    v_mfma_f32_16x16x32_bf16 v[168:171], v[168:171], v[8:11], 0
    v_mfma_f32_16x16x32_bf16 v[172:175], v[172:175], v[8:11], 0
    v_mov_b32_dpp v32, v144 quad_perm:[0,0,0,0] row_mask:0xf bank_mask:0xa
    v_mov_b32_dpp v33, v148 quad_perm:[0,0,0,0] row_mask:0xf bank_mask:0xa
    v_mov_b32_dpp v34, v152 quad_perm:[0,0,0,0] row_mask:0xf bank_mask:0xa
    v_mov_b32_dpp v35, v156 quad_perm:[0,0,0,0] row_mask:0xf bank_mask:0xa
    v_add_f32_dpp v32, v145, v32 quad_perm:[1,1,1,1] row_mask:0xf bank_mask:0xa
    v_add_f32_dpp v33, v149, v33 quad_perm:[1,1,1,1] row_mask:0xf bank_mask:0xa
    v_add_f32_dpp v34, v153, v34 quad_perm:[1,1,1,1] row_mask:0xf bank_mask:0xa
    v_add_f32_dpp v35, v157, v35 quad_perm:[1,1,1,1] row_mask:0xf bank_mask:0xa
    v_add_f32_dpp v32, v146, v32 quad_perm:[2,2,2,2] row_mask:0xf bank_mask:0xa
    v_add_f32_dpp v33, v150, v33 quad_perm:[2,2,2,2] row_mask:0xf bank_mask:0xa
    v_add_f32_dpp v34, v154, v34 quad_perm:[2,2,2,2] row_mask:0xf bank_mask:0xa
    v_add_f32_dpp v35, v158, v35 quad_perm:[2,2,2,2] row_mask:0xf bank_mask:0xa
    v_add_f32_dpp v32, v147, v32 quad_perm:[3,3,3,3] row_mask:0xf bank_mask:0xa
    v_add_f32_dpp v33, v151, v33 quad_perm:[3,3,3,3] row_mask:0xf bank_mask:0xa
    v_add_f32_dpp v34, v155, v34 quad_perm:[3,3,3,3] row_mask:0xf bank_mask:0xa
    v_add_f32_dpp v35, v159, v35 quad_perm:[3,3,3,3] row_mask:0xf bank_mask:0xa
    s_waitcnt vmcnt(48)
    v_mfma_f32_16x16x32_bf16 v[176:179], v[176:179], v[8:11], 0
    v_mfma_f32_16x16x32_bf16 v[180:183], v[180:183], v[8:11], 0
    v_mfma_f32_16x16x32_bf16 v[184:187], v[184:187], v[8:11], 0
    v_mfma_f32_16x16x32_bf16 v[188:191], v[188:191], v[8:11], 0
    v_mov_b32_dpp v36, v160 quad_perm:[0,0,0,0] row_mask:0xf bank_mask:0x5
    v_mov_b32_dpp v37, v164 quad_perm:[0,0,0,0] row_mask:0xf bank_mask:0x5
    v_mov_b32_dpp v38, v168 quad_perm:[0,0,0,0] row_mask:0xf bank_mask:0x5
    v_mov_b32_dpp v39, v172 quad_perm:[0,0,0,0] row_mask:0xf bank_mask:0x5
    v_add_f32_dpp v36, v161, v36 quad_perm:[1,1,1,1] row_mask:0xf bank_mask:0x5
    v_add_f32_dpp v37, v165, v37 quad_perm:[1,1,1,1] row_mask:0xf bank_mask:0x5
    v_add_f32_dpp v38, v169, v38 quad_perm:[1,1,1,1] row_mask:0xf bank_mask:0x5
    v_add_f32_dpp v39, v173, v39 quad_perm:[1,1,1,1] row_mask:0xf bank_mask:0x5
    v_add_f32_dpp v36, v162, v36 quad_perm:[2,2,2,2] row_mask:0xf bank_mask:0x5
    v_add_f32_dpp v37, v166, v37 quad_perm:[2,2,2,2] row_mask:0xf bank_mask:0x5
    v_add_f32_dpp v38, v170, v38 quad_perm:[2,2,2,2] row_mask:0xf bank_mask:0x5
    v_add_f32_dpp v39, v174, v39 quad_perm:[2,2,2,2] row_mask:0xf bank_mask:0x5
    v_add_f32_dpp v36, v163, v36 quad_perm:[3,3,3,3] row_mask:0xf bank_mask:0x5
    v_add_f32_dpp v37, v167, v37 quad_perm:[3,3,3,3] row_mask:0xf bank_mask:0x5
    v_add_f32_dpp v38, v171, v38 quad_perm:[3,3,3,3] row_mask:0xf bank_mask:0x5
    v_add_f32_dpp v39, v175, v39 quad_perm:[3,3,3,3] row_mask:0xf bank_mask:0x5
    s_waitcnt vmcnt(44)
    v_mfma_f32_16x16x32_bf16 v[192:195], v[192:195], v[8:11], 0
    v_mfma_f32_16x16x32_bf16 v[196:199], v[196:199], v[8:11], 0
    v_mfma_f32_16x16x32_bf16 v[200:203], v[200:203], v[8:11], 0
    v_mfma_f32_16x16x32_bf16 v[204:207], v[204:207], v[8:11], 0
    v_mov_b32_dpp v36, v176 quad_perm:[0,0,0,0] row_mask:0xf bank_mask:0xa
    v_mov_b32_dpp v37, v180 quad_perm:[0,0,0,0] row_mask:0xf bank_mask:0xa
    v_mov_b32_dpp v38, v184 quad_perm:[0,0,0,0] row_mask:0xf bank_mask:0xa
    v_mov_b32_dpp v39, v188 quad_perm:[0,0,0,0] row_mask:0xf bank_mask:0xa
    v_add_f32_dpp v36, v177, v36 quad_perm:[1,1,1,1] row_mask:0xf bank_mask:0xa
    v_add_f32_dpp v37, v181, v37 quad_perm:[1,1,1,1] row_mask:0xf bank_mask:0xa
    v_add_f32_dpp v38, v185, v38 quad_perm:[1,1,1,1] row_mask:0xf bank_mask:0xa
    v_add_f32_dpp v39, v189, v39 quad_perm:[1,1,1,1] row_mask:0xf bank_mask:0xa
    v_add_f32_dpp v36, v178, v36 quad_perm:[2,2,2,2] row_mask:0xf bank_mask:0xa
    v_add_f32_dpp v37, v182, v37 quad_perm:[2,2,2,2] row_mask:0xf bank_mask:0xa
    v_add_f32_dpp v38, v186, v38 quad_perm:[2,2,2,2] row_mask:0xf bank_mask:0xa
    v_add_f32_dpp v39, v190, v39 quad_perm:[2,2,2,2] row_mask:0xf bank_mask:0xa
    v_add_f32_dpp v36, v179, v36 quad_perm:[3,3,3,3] row_mask:0xf bank_mask:0xa
    v_add_f32_dpp v37, v183, v37 quad_perm:[3,3,3,3] row_mask:0xf bank_mask:0xa
    v_add_f32_dpp v38, v187, v38 quad_perm:[3,3,3,3] row_mask:0xf bank_mask:0xa
    v_add_f32_dpp v39, v191, v39 quad_perm:[3,3,3,3] row_mask:0xf bank_mask:0xa
    s_waitcnt vmcnt(40)
    v_mfma_f32_16x16x32_bf16 v[208:211], v[208:211], v[8:11], 0
    v_mfma_f32_16x16x32_bf16 v[212:215], v[212:215], v[8:11], 0
    v_mfma_f32_16x16x32_bf16 v[216:219], v[216:219], v[8:11], 0
    v_mfma_f32_16x16x32_bf16 v[220:223], v[220:223], v[8:11], 0
    v_mov_b32_dpp v40, v192 quad_perm:[0,0,0,0] row_mask:0xf bank_mask:0x5
    v_mov_b32_dpp v41, v196 quad_perm:[0,0,0,0] row_mask:0xf bank_mask:0x5
    v_mov_b32_dpp v42, v200 quad_perm:[0,0,0,0] row_mask:0xf bank_mask:0x5
    v_mov_b32_dpp v43, v204 quad_perm:[0,0,0,0] row_mask:0xf bank_mask:0x5
    v_add_f32_dpp v40, v193, v40 quad_perm:[1,1,1,1] row_mask:0xf bank_mask:0x5
    v_add_f32_dpp v41, v197, v41 quad_perm:[1,1,1,1] row_mask:0xf bank_mask:0x5
    v_add_f32_dpp v42, v201, v42 quad_perm:[1,1,1,1] row_mask:0xf bank_mask:0x5
    v_add_f32_dpp v43, v205, v43 quad_perm:[1,1,1,1] row_mask:0xf bank_mask:0x5
    v_add_f32_dpp v40, v194, v40 quad_perm:[2,2,2,2] row_mask:0xf bank_mask:0x5
    v_add_f32_dpp v41, v198, v41 quad_perm:[2,2,2,2] row_mask:0xf bank_mask:0x5
    v_add_f32_dpp v42, v202, v42 quad_perm:[2,2,2,2] row_mask:0xf bank_mask:0x5
    v_add_f32_dpp v43, v206, v43 quad_perm:[2,2,2,2] row_mask:0xf bank_mask:0x5
    v_add_f32_dpp v40, v195, v40 quad_perm:[3,3,3,3] row_mask:0xf bank_mask:0x5
    v_add_f32_dpp v41, v199, v41 quad_perm:[3,3,3,3] row_mask:0xf bank_mask:0x5
    v_add_f32_dpp v42, v203, v42 quad_perm:[3,3,3,3] row_mask:0xf bank_mask:0x5
    v_add_f32_dpp v43, v207, v43 quad_perm:[3,3,3,3] row_mask:0xf bank_mask:0x5
    s_waitcnt vmcnt(36)
    v_mfma_f32_16x16x32_bf16 v[224:227], v[224:227], v[8:11], 0
    v_mfma_f32_16x16x32_bf16 v[228:231], v[228:231], v[8:11], 0
    v_mfma_f32_16x16x32_bf16 v[232:235], v[232:235], v[8:11], 0
    v_mfma_f32_16x16x32_bf16 v[236:239], v[236:239], v[8:11], 0
    v_mov_b32_dpp v40, v208 quad_perm:[0,0,0,0] row_mask:0xf bank_mask:0xa
    v_mov_b32_dpp v41, v212 quad_perm:[0,0,0,0] row_mask:0xf bank_mask:0xa
    v_mov_b32_dpp v42, v216 quad_perm:[0,0,0,0] row_mask:0xf bank_mask:0xa
    v_mov_b32_dpp v43, v220 quad_perm:[0,0,0,0] row_mask:0xf bank_mask:0xa
    v_add_f32_dpp v40, v209, v40 quad_perm:[1,1,1,1] row_mask:0xf bank_mask:0xa
    v_add_f32_dpp v41, v213, v41 quad_perm:[1,1,1,1] row_mask:0xf bank_mask:0xa
    v_add_f32_dpp v42, v217, v42 quad_perm:[1,1,1,1] row_mask:0xf bank_mask:0xa
    v_add_f32_dpp v43, v221, v43 quad_perm:[1,1,1,1] row_mask:0xf bank_mask:0xa
    v_add_f32_dpp v40, v210, v40 quad_perm:[2,2,2,2] row_mask:0xf bank_mask:0xa
    v_add_f32_dpp v41, v214, v41 quad_perm:[2,2,2,2] row_mask:0xf bank_mask:0xa
    v_add_f32_dpp v42, v218, v42 quad_perm:[2,2,2,2] row_mask:0xf bank_mask:0xa
    v_add_f32_dpp v43, v222, v43 quad_perm:[2,2,2,2] row_mask:0xf bank_mask:0xa
    v_add_f32_dpp v40, v211, v40 quad_perm:[3,3,3,3] row_mask:0xf bank_mask:0xa
    v_add_f32_dpp v41, v215, v41 quad_perm:[3,3,3,3] row_mask:0xf bank_mask:0xa
    v_add_f32_dpp v42, v219, v42 quad_perm:[3,3,3,3] row_mask:0xf bank_mask:0xa
    v_add_f32_dpp v43, v223, v43 quad_perm:[3,3,3,3] row_mask:0xf bank_mask:0xa
    s_waitcnt vmcnt(32)
    v_mfma_f32_16x16x32_bf16 v[240:243], v[240:243], v[8:11], 0
    v_mfma_f32_16x16x32_bf16 v[244:247], v[244:247], v[8:11], 0
    v_mfma_f32_16x16x32_bf16 v[248:251], v[248:251], v[8:11], 0
    v_mfma_f32_16x16x32_bf16 v[252:255], v[252:255], v[8:11], 0
    v_mov_b32_dpp v44, v224 quad_perm:[0,0,0,0] row_mask:0xf bank_mask:0x5
    v_mov_b32_dpp v45, v228 quad_perm:[0,0,0,0] row_mask:0xf bank_mask:0x5
    v_mov_b32_dpp v46, v232 quad_perm:[0,0,0,0] row_mask:0xf bank_mask:0x5
    v_mov_b32_dpp v47, v236 quad_perm:[0,0,0,0] row_mask:0xf bank_mask:0x5
    v_add_f32_dpp v44, v225, v44 quad_perm:[1,1,1,1] row_mask:0xf bank_mask:0x5
    v_add_f32_dpp v45, v229, v45 quad_perm:[1,1,1,1] row_mask:0xf bank_mask:0x5
    v_add_f32_dpp v46, v233, v46 quad_perm:[1,1,1,1] row_mask:0xf bank_mask:0x5
    v_add_f32_dpp v47, v237, v47 quad_perm:[1,1,1,1] row_mask:0xf bank_mask:0x5
    v_add_f32_dpp v44, v226, v44 quad_perm:[2,2,2,2] row_mask:0xf bank_mask:0x5
    v_add_f32_dpp v45, v230, v45 quad_perm:[2,2,2,2] row_mask:0xf bank_mask:0x5
    v_add_f32_dpp v46, v234, v46 quad_perm:[2,2,2,2] row_mask:0xf bank_mask:0x5
    v_add_f32_dpp v47, v238, v47 quad_perm:[2,2,2,2] row_mask:0xf bank_mask:0x5
    v_add_f32_dpp v44, v227, v44 quad_perm:[3,3,3,3] row_mask:0xf bank_mask:0x5
    v_add_f32_dpp v45, v231, v45 quad_perm:[3,3,3,3] row_mask:0xf bank_mask:0x5
    v_add_f32_dpp v46, v235, v46 quad_perm:[3,3,3,3] row_mask:0xf bank_mask:0x5
    v_add_f32_dpp v47, v239, v47 quad_perm:[3,3,3,3] row_mask:0xf bank_mask:0x5
    v_mov_b32_dpp v44, v240 quad_perm:[0,0,0,0] row_mask:0xf bank_mask:0xa
    v_mov_b32_dpp v45, v244 quad_perm:[0,0,0,0] row_mask:0xf bank_mask:0xa
    v_mov_b32_dpp v46, v248 quad_perm:[0,0,0,0] row_mask:0xf bank_mask:0xa
    v_mov_b32_dpp v47, v252 quad_perm:[0,0,0,0] row_mask:0xf bank_mask:0xa
    v_add_f32_dpp v44, v241, v44 quad_perm:[1,1,1,1] row_mask:0xf bank_mask:0xa
    v_add_f32_dpp v45, v245, v45 quad_perm:[1,1,1,1] row_mask:0xf bank_mask:0xa
    v_add_f32_dpp v46, v249, v46 quad_perm:[1,1,1,1] row_mask:0xf bank_mask:0xa
    v_add_f32_dpp v47, v253, v47 quad_perm:[1,1,1,1] row_mask:0xf bank_mask:0xa
    v_add_f32_dpp v44, v242, v44 quad_perm:[2,2,2,2] row_mask:0xf bank_mask:0xa
    v_add_f32_dpp v45, v246, v45 quad_perm:[2,2,2,2] row_mask:0xf bank_mask:0xa
    v_add_f32_dpp v46, v250, v46 quad_perm:[2,2,2,2] row_mask:0xf bank_mask:0xa
    v_add_f32_dpp v47, v254, v47 quad_perm:[2,2,2,2] row_mask:0xf bank_mask:0xa
    v_add_f32_dpp v44, v243, v44 quad_perm:[3,3,3,3] row_mask:0xf bank_mask:0xa
    v_add_f32_dpp v45, v247, v45 quad_perm:[3,3,3,3] row_mask:0xf bank_mask:0xa
    v_add_f32_dpp v46, v251, v46 quad_perm:[3,3,3,3] row_mask:0xf bank_mask:0xa
    v_add_f32_dpp v47, v255, v47 quad_perm:[3,3,3,3] row_mask:0xf bank_mask:0xa
    s_waitcnt vmcnt(20)
    ds_read_b128 v[128:131], v30 offset:0
    ds_read_b128 v[132:135], v30 offset:1024
    ds_read_b128 v[136:139], v30 offset:2048
    ds_read_b128 v[140:143], v30 offset:3072
    ds_read_b128 v[144:147], v30 offset:4096
    ds_read_b128 v[148:151], v30 offset:5120
    ds_read_b128 v[152:155], v30 offset:6144
    ds_read_b128 v[156:159], v30 offset:7168
    ds_read_b128 v[160:163], v30 offset:8192
    ds_read_b128 v[164:167], v30 offset:9216
    ds_read_b128 v[168:171], v30 offset:10240
    ds_read_b128 v[172:175], v30 offset:11264
    v_max3_f32 v3, v32, v33, v34
    v_max3_f32 v4, v35, v36, v37
    v_max3_f32 v5, v38, v39, v40
    v_max3_f32 v3, v3, v41, v42
    v_max3_f32 v4, v4, v43, v44
    v_max3_f32 v5, v5, v45, v46
    v_max3_f32 v3, v3, v4, v47
    v_max_f32 v28, v3, v5
    s_nop 1
    v_max_f32_dpp v28, v28, v28 row_half_mirror row_mask:0xf bank_mask:0xf
    v_mov_b32 v3, v28
    s_nop 1
    v_permlane16_swap_b32 v28, v3
    v_max_f32 v28, v28, v3
    v_mov_b32 v3, v28
    s_nop 1
    v_permlane32_swap_b32 v28, v3
    v_max_f32 v28, v28, v3
    v_mul_f32 v28, s46, v28
    v_fma_f32 v32, v32, s46, -v28
    v_fma_f32 v33, v33, s46, -v28
    v_fma_f32 v34, v34, s46, -v28
    v_fma_f32 v35, v35, s46, -v28
    v_fma_f32 v36, v36, s46, -v28
    v_fma_f32 v37, v37, s46, -v28
    v_fma_f32 v38, v38, s46, -v28
    v_fma_f32 v39, v39, s46, -v28
    v_fma_f32 v40, v40, s46, -v28
    v_fma_f32 v41, v41, s46, -v28
    v_fma_f32 v42, v42, s46, -v28
    v_fma_f32 v43, v43, s46, -v28
    v_fma_f32 v44, v44, s46, -v28
    v_fma_f32 v45, v45, s46, -v28
    v_fma_f32 v46, v46, s46, -v28
    v_fma_f32 v47, v47, s46, -v28
    v_exp_f32 v32, v32
    v_exp_f32 v33, v33
    v_exp_f32 v34, v34
    v_exp_f32 v35, v35
    v_exp_f32 v36, v36
    v_exp_f32 v37, v37
    v_exp_f32 v38, v38
    v_exp_f32 v39, v39
    v_exp_f32 v40, v40
    v_exp_f32 v41, v41
    v_exp_f32 v42, v42
    v_exp_f32 v43, v43
    v_exp_f32 v44, v44
    v_exp_f32 v45, v45
    v_exp_f32 v46, v46
    v_exp_f32 v47, v47
    v_add_f32 v29, v32, v33
    v_add_f32 v3, v34, v35
    v_add_f32 v29, v29, v36
    v_add_f32 v3, v3, v37
    v_add_f32 v29, v29, v38
    v_add_f32 v3, v3, v39
    v_add_f32 v29, v29, v40
    v_add_f32 v3, v3, v41
    v_add_f32 v29, v29, v42
    v_add_f32 v3, v3, v43
    v_add_f32 v29, v29, v44
    v_add_f32 v3, v3, v45
    v_add_f32 v29, v29, v46
    v_add_f32 v3, v3, v47
    v_add_f32 v29, v29, v3
    v_cvt_pk_bf16_f32 v32, v32, v32
    v_cvt_pk_bf16_f32 v33, v33, v33
    v_cvt_pk_bf16_f32 v34, v34, v34
    v_cvt_pk_bf16_f32 v35, v35, v35
    v_cvt_pk_bf16_f32 v36, v36, v36
    v_cvt_pk_bf16_f32 v37, v37, v37
    v_cvt_pk_bf16_f32 v38, v38, v38
    v_cvt_pk_bf16_f32 v39, v39, v39
    v_cvt_pk_bf16_f32 v40, v40, v40
    v_cvt_pk_bf16_f32 v41, v41, v41
    v_cvt_pk_bf16_f32 v42, v42, v42
    v_cvt_pk_bf16_f32 v43, v43, v43
    v_cvt_pk_bf16_f32 v44, v44, v44
    v_cvt_pk_bf16_f32 v45, v45, v45
    v_cvt_pk_bf16_f32 v46, v46, v46
    v_cvt_pk_bf16_f32 v47, v47, v47
    s_nop 1
    v_add_f32_dpp v29, v29, v29 row_half_mirror row_mask:0xf bank_mask:0xf
    v_mov_b32 v3, v29
    s_nop 1
    v_permlane16_swap_b32 v29, v3
    v_add_f32 v29, v29, v3
    v_mov_b32 v3, v29
    s_nop 1
    v_permlane32_swap_b32 v29, v3
    v_add_f32 v29, v29, v3
    v_lshlrev_b32 v4, 3, v7
    s_lshl_b32 s3, s36, 3
    v_add_u32 v4, s3, v4
    s_mov_b64 exec, 0x101
    ds_write_b64 v4, v[28:29] offset:576
    s_mov_b64 exec, 1
    v_mov_b32 v3, 1
    ds_add_u32 v0, v3 offset:520
    s_mov_b64 exec, -1
    s_branch L_pv
L_lateV:
    s_mov_b32 s47, 8388608
L_wQ2:
    ds_read_b32 v3, v0 offset:512
    s_waitcnt lgkmcnt(0)
    v_readfirstlane_b32 s3, v3
    s_cmp_ge_u32 s3, 2
    s_cbranch_scc1 L_gQ2
    s_sub_u32 s47, s47, 1
    s_cbranch_scc1 L_end
    s_sleep 4
    s_branch L_wQ2
L_gQ2:
    ds_read_b128 v[8:11], v6 offset:0
    s_waitcnt lgkmcnt(0)
    s_add_u32 s44, s43, 0x9e3779b9
    s_waitcnt lgkmcnt(0)
    v_readfirstlane_b32 s101, v31
    s_sub_u32 s98, s98, s100
    s_sub_u32 s3, s98, s101
    s_cmp_lt_i32 s3, 0
    s_cselect_b64 vcc, -1, 0
    s_add_u32 s100, s100, 58
    s_memrealtime s[98:99]
    ds_read_b32 v31, v0 offset:532
    s_waitcnt vmcnt(6)
    s_cbranch_vccz L_t59
    s_waitcnt vmcnt(4)
L_t59:
    s_xor_b32 s42, s41, 0
    s_add_u32 m0, s48, 0
    s_nop 0
    buffer_load_dwordx4 v2, s[12:15], s42 offen offset:0 nt lds
    s_waitcnt vmcnt(6)
    s_cbranch_vccz L_t60
    s_waitcnt vmcnt(4)
L_t60:
    buffer_load_dwordx4 v2, s[12:15], s42 offen offset:1024 nt lds
    s_waitcnt vmcnt(30)
    v_mfma_f32_16x16x32_bf16 v[128:131], v[128:131], v[8:11], 0
    v_mfma_f32_16x16x32_bf16 v[132:135], v[132:135], v[8:11], 0
    v_mfma_f32_16x16x32_bf16 v[136:139], v[136:139], v[8:11], 0
    v_mfma_f32_16x16x32_bf16 v[140:143], v[140:143], v[8:11], 0
    s_waitcnt vmcnt(6)
    s_cbranch_vccz L_t61
    s_waitcnt vmcnt(4)
L_t61:
    buffer_load_dwordx4 v2, s[12:15], s42 offen offset:2048 nt lds
    s_waitcnt vmcnt(27)
    v_mfma_f32_16x16x32_bf16 v[144:147], v[144:147], v[8:11], 0
    v_mfma_f32_16x16x32_bf16 v[148:151], v[148:151], v[8:11], 0
    v_mfma_f32_16x16x32_bf16 v[152:155], v[152:155], v[8:11], 0
    v_mfma_f32_16x16x32_bf16 v[156:159], v[156:159], v[8:11], 0
    s_waitcnt vmcnt(6)
    s_cbranch_vccz L_t62
    s_waitcnt vmcnt(4)
L_t62:
    buffer_load_dwordx4 v2, s[12:15], s42 offen offset:3072 nt lds
    s_nop 1
    v_mov_b32_dpp v32, v128 quad_perm:[0,0,0,0] row_mask:0xf bank_mask:0x5
    v_mov_b32_dpp v33, v132 quad_perm:[0,0,0,0] row_mask:0xf bank_mask:0x5
    v_mov_b32_dpp v34, v136 quad_perm:[0,0,0,0] row_mask:0xf bank_mask:0x5
    v_mov_b32_dpp v35, v140 quad_perm:[0,0,0,0] row_mask:0xf bank_mask:0x5
    v_add_f32_dpp v32, v129, v32 quad_perm:[1,1,1,1] row_mask:0xf bank_mask:0x5
    v_add_f32_dpp v33, v133, v33 quad_perm:[1,1,1,1] row_mask:0xf bank_mask:0x5
    v_add_f32_dpp v34, v137, v34 quad_perm:[1,1,1,1] row_mask:0xf bank_mask:0x5
    v_add_f32_dpp v35, v141, v35 quad_perm:[1,1,1,1] row_mask:0xf bank_mask:0x5
    v_add_f32_dpp v32, v130, v32 quad_perm:[2,2,2,2] row_mask:0xf bank_mask:0x5
    v_add_f32_dpp v33, v134, v33 quad_perm:[2,2,2,2] row_mask:0xf bank_mask:0x5
    v_add_f32_dpp v34, v138, v34 quad_perm:[2,2,2,2] row_mask:0xf bank_mask:0x5
    v_add_f32_dpp v35, v142, v35 quad_perm:[2,2,2,2] row_mask:0xf bank_mask:0x5
    v_add_f32_dpp v32, v131, v32 quad_perm:[3,3,3,3] row_mask:0xf bank_mask:0x5
    v_add_f32_dpp v33, v135, v33 quad_perm:[3,3,3,3] row_mask:0xf bank_mask:0x5
    v_add_f32_dpp v34, v139, v34 quad_perm:[3,3,3,3] row_mask:0xf bank_mask:0x5
    v_add_f32_dpp v35, v143, v35 quad_perm:[3,3,3,3] row_mask:0xf bank_mask:0x5
    s_waitcnt lgkmcnt(0)
    v_readfirstlane_b32 s101, v31
    s_sub_u32 s98, s98, s100
    s_sub_u32 s3, s98, s101
    s_cmp_lt_i32 s3, 0
    s_cselect_b64 vcc, -1, 0
    s_add_u32 s100, s100, 58
    s_or_b32 s3, s98, 1
    v_mov_b32 v22, s3
    s_mov_b64 exec, s[62:63]
    ds_write_b32 v23, v22 offset:784
    s_mov_b64 exec, -1
    s_memrealtime s[98:99]
    ds_read_b32 v31, v0 offset:532
    s_waitcnt vmcnt(6)
    s_cbranch_vccz L_t63
    s_waitcnt vmcnt(4)
L_t63:
    s_xor_b32 s42, s41, 65536
    s_add_u32 m0, s48, 4096
    s_nop 0
    buffer_load_dwordx4 v2, s[12:15], s42 offen offset:0 nt lds
    s_waitcnt vmcnt(25)
    v_mfma_f32_16x16x32_bf16 v[160:163], v[160:163], v[8:11], 0
    v_mfma_f32_16x16x32_bf16 v[164:167], v[164:167], v[8:11], 0
    v_mfma_f32_16x16x32_bf16 v[168:171], v[168:171], v[8:11], 0
    v_mfma_f32_16x16x32_bf16 v[172:175], v[172:175], v[8:11], 0
    s_waitcnt vmcnt(6)
    s_cbranch_vccz L_t64
    s_waitcnt vmcnt(4)
L_t64:
    buffer_load_dwordx4 v2, s[12:15], s42 offen offset:1024 nt lds
    v_mov_b32_dpp v32, v144 quad_perm:[0,0,0,0] row_mask:0xf bank_mask:0xa
    v_mov_b32_dpp v33, v148 quad_perm:[0,0,0,0] row_mask:0xf bank_mask:0xa
    v_mov_b32_dpp v34, v152 quad_perm:[0,0,0,0] row_mask:0xf bank_mask:0xa
    v_mov_b32_dpp v35, v156 quad_perm:[0,0,0,0] row_mask:0xf bank_mask:0xa
    v_add_f32_dpp v32, v145, v32 quad_perm:[1,1,1,1] row_mask:0xf bank_mask:0xa
    v_add_f32_dpp v33, v149, v33 quad_perm:[1,1,1,1] row_mask:0xf bank_mask:0xa
    v_add_f32_dpp v34, v153, v34 quad_perm:[1,1,1,1] row_mask:0xf bank_mask:0xa
    v_add_f32_dpp v35, v157, v35 quad_perm:[1,1,1,1] row_mask:0xf bank_mask:0xa
    v_add_f32_dpp v32, v146, v32 quad_perm:[2,2,2,2] row_mask:0xf bank_mask:0xa
    v_add_f32_dpp v33, v150, v33 quad_perm:[2,2,2,2] row_mask:0xf bank_mask:0xa
    v_add_f32_dpp v34, v154, v34 quad_perm:[2,2,2,2] row_mask:0xf bank_mask:0xa
    v_add_f32_dpp v35, v158, v35 quad_perm:[2,2,2,2] row_mask:0xf bank_mask:0xa
    v_add_f32_dpp v32, v147, v32 quad_perm:[3,3,3,3] row_mask:0xf bank_mask:0xa
    v_add_f32_dpp v33, v151, v33 quad_perm:[3,3,3,3] row_mask:0xf bank_mask:0xa
    v_add_f32_dpp v34, v155, v34 quad_perm:[3,3,3,3] row_mask:0xf bank_mask:0xa
    v_add_f32_dpp v35, v159, v35 quad_perm:[3,3,3,3] row_mask:0xf bank_mask:0xa
    s_waitcnt vmcnt(6)
    s_cbranch_vccz L_t65
    s_waitcnt vmcnt(4)
L_t65:
    buffer_load_dwordx4 v2, s[12:15], s42 offen offset:2048 nt lds
    s_waitcnt vmcnt(23)
    v_mfma_f32_16x16x32_bf16 v[176:179], v[176:179], v[8:11], 0
    v_mfma_f32_16x16x32_bf16 v[180:183], v[180:183], v[8:11], 0
    v_mfma_f32_16x16x32_bf16 v[184:187], v[184:187], v[8:11], 0
    v_mfma_f32_16x16x32_bf16 v[188:191], v[188:191], v[8:11], 0
    s_waitcnt vmcnt(6)
    s_cbranch_vccz L_t66
    s_waitcnt vmcnt(4)
L_t66:
    buffer_load_dwordx4 v2, s[12:15], s42 offen offset:3072 nt lds
    v_mov_b32_dpp v36, v160 quad_perm:[0,0,0,0] row_mask:0xf bank_mask:0x5
    v_mov_b32_dpp v37, v164 quad_perm:[0,0,0,0] row_mask:0xf bank_mask:0x5
    v_mov_b32_dpp v38, v168 quad_perm:[0,0,0,0] row_mask:0xf bank_mask:0x5
    v_mov_b32_dpp v39, v172 quad_perm:[0,0,0,0] row_mask:0xf bank_mask:0x5
    v_add_f32_dpp v36, v161, v36 quad_perm:[1,1,1,1] row_mask:0xf bank_mask:0x5
    v_add_f32_dpp v37, v165, v37 quad_perm:[1,1,1,1] row_mask:0xf bank_mask:0x5
    v_add_f32_dpp v38, v169, v38 quad_perm:[1,1,1,1] row_mask:0xf bank_mask:0x5
    v_add_f32_dpp v39, v173, v39 quad_perm:[1,1,1,1] row_mask:0xf bank_mask:0x5
    v_add_f32_dpp v36, v162, v36 quad_perm:[2,2,2,2] row_mask:0xf bank_mask:0x5
    v_add_f32_dpp v37, v166, v37 quad_perm:[2,2,2,2] row_mask:0xf bank_mask:0x5
    v_add_f32_dpp v38, v170, v38 quad_perm:[2,2,2,2] row_mask:0xf bank_mask:0x5
    v_add_f32_dpp v39, v174, v39 quad_perm:[2,2,2,2] row_mask:0xf bank_mask:0x5
    v_add_f32_dpp v36, v163, v36 quad_perm:[3,3,3,3] row_mask:0xf bank_mask:0x5
    v_add_f32_dpp v37, v167, v37 quad_perm:[3,3,3,3] row_mask:0xf bank_mask:0x5
    v_add_f32_dpp v38, v171, v38 quad_perm:[3,3,3,3] row_mask:0xf bank_mask:0x5
    v_add_f32_dpp v39, v175, v39 quad_perm:[3,3,3,3] row_mask:0xf bank_mask:0x5
    s_waitcnt lgkmcnt(0)
    v_readfirstlane_b32 s101, v31
    s_sub_u32 s98, s98, s100
    s_sub_u32 s3, s98, s101
    s_cmp_lt_i32 s3, 0
    s_cselect_b64 vcc, -1, 0
    s_add_u32 s100, s100, 58
    s_memrealtime s[98:99]
    ds_read_b32 v31, v0 offset:532
    s_waitcnt vmcnt(6)
    s_cbranch_vccz L_t67
    s_waitcnt vmcnt(4)
L_t67:
    s_xor_b32 s42, s41, 32768
    s_add_u32 m0, s48, 8192
    s_nop 0
    buffer_load_dwordx4 v2, s[12:15], s42 offen offset:0 nt lds
    s_waitcnt vmcnt(21)
    v_mfma_f32_16x16x32_bf16 v[192:195], v[192:195], v[8:11], 0
    v_mfma_f32_16x16x32_bf16 v[196:199], v[196:199], v[8:11], 0
    v_mfma_f32_16x16x32_bf16 v[200:203], v[200:203], v[8:11], 0
    v_mfma_f32_16x16x32_bf16 v[204:207], v[204:207], v[8:11], 0
    s_waitcnt vmcnt(6)
    s_cbranch_vccz L_t68
    s_waitcnt vmcnt(4)
L_t68:
    buffer_load_dwordx4 v2, s[12:15], s42 offen offset:1024 nt lds
    v_mov_b32_dpp v36, v176 quad_perm:[0,0,0,0] row_mask:0xf bank_mask:0xa
    v_mov_b32_dpp v37, v180 quad_perm:[0,0,0,0] row_mask:0xf bank_mask:0xa
    v_mov_b32_dpp v38, v184 quad_perm:[0,0,0,0] row_mask:0xf bank_mask:0xa
    v_mov_b32_dpp v39, v188 quad_perm:[0,0,0,0] row_mask:0xf bank_mask:0xa
    v_add_f32_dpp v36, v177, v36 quad_perm:[1,1,1,1] row_mask:0xf bank_mask:0xa
    v_add_f32_dpp v37, v181, v37 quad_perm:[1,1,1,1] row_mask:0xf bank_mask:0xa
    v_add_f32_dpp v38, v185, v38 quad_perm:[1,1,1,1] row_mask:0xf bank_mask:0xa
    v_add_f32_dpp v39, v189, v39 quad_perm:[1,1,1,1] row_mask:0xf bank_mask:0xa
    v_add_f32_dpp v36, v178, v36 quad_perm:[2,2,2,2] row_mask:0xf bank_mask:0xa
    v_add_f32_dpp v37, v182, v37 quad_perm:[2,2,2,2] row_mask:0xf bank_mask:0xa
    v_add_f32_dpp v38, v186, v38 quad_perm:[2,2,2,2] row_mask:0xf bank_mask:0xa
    v_add_f32_dpp v39, v190, v39 quad_perm:[2,2,2,2] row_mask:0xf bank_mask:0xa
    v_add_f32_dpp v36, v179, v36 quad_perm:[3,3,3,3] row_mask:0xf bank_mask:0xa
    v_add_f32_dpp v37, v183, v37 quad_perm:[3,3,3,3] row_mask:0xf bank_mask:0xa
    v_add_f32_dpp v38, v187, v38 quad_perm:[3,3,3,3] row_mask:0xf bank_mask:0xa
    v_add_f32_dpp v39, v191, v39 quad_perm:[3,3,3,3] row_mask:0xf bank_mask:0xa
    s_waitcnt vmcnt(6)
    s_cbranch_vccz L_t69
    s_waitcnt vmcnt(4)
L_t69:
    buffer_load_dwordx4 v2, s[12:15], s42 offen offset:2048 nt lds
    s_waitcnt vmcnt(19)
    v_mfma_f32_16x16x32_bf16 v[208:211], v[208:211], v[8:11], 0
    v_mfma_f32_16x16x32_bf16 v[212:215], v[212:215], v[8:11], 0
    v_mfma_f32_16x16x32_bf16 v[216:219], v[216:219], v[8:11], 0
    v_mfma_f32_16x16x32_bf16 v[220:223], v[220:223], v[8:11], 0
    s_waitcnt vmcnt(6)
    s_cbranch_vccz L_t70
    s_waitcnt vmcnt(4)
L_t70:
    buffer_load_dwordx4 v2, s[12:15], s42 offen offset:3072 nt lds
    v_mov_b32_dpp v40, v192 quad_perm:[0,0,0,0] row_mask:0xf bank_mask:0x5
    v_mov_b32_dpp v41, v196 quad_perm:[0,0,0,0] row_mask:0xf bank_mask:0x5
    v_mov_b32_dpp v42, v200 quad_perm:[0,0,0,0] row_mask:0xf bank_mask:0x5
    v_mov_b32_dpp v43, v204 quad_perm:[0,0,0,0] row_mask:0xf bank_mask:0x5
    v_add_f32_dpp v40, v193, v40 quad_perm:[1,1,1,1] row_mask:0xf bank_mask:0x5
    v_add_f32_dpp v41, v197, v41 quad_perm:[1,1,1,1] row_mask:0xf bank_mask:0x5
    v_add_f32_dpp v42, v201, v42 quad_perm:[1,1,1,1] row_mask:0xf bank_mask:0x5
    v_add_f32_dpp v43, v205, v43 quad_perm:[1,1,1,1] row_mask:0xf bank_mask:0x5
    v_add_f32_dpp v40, v194, v40 quad_perm:[2,2,2,2] row_mask:0xf bank_mask:0x5
    v_add_f32_dpp v41, v198, v41 quad_perm:[2,2,2,2] row_mask:0xf bank_mask:0x5
    v_add_f32_dpp v42, v202, v42 quad_perm:[2,2,2,2] row_mask:0xf bank_mask:0x5
    v_add_f32_dpp v43, v206, v43 quad_perm:[2,2,2,2] row_mask:0xf bank_mask:0x5
    v_add_f32_dpp v40, v195, v40 quad_perm:[3,3,3,3] row_mask:0xf bank_mask:0x5
    v_add_f32_dpp v41, v199, v41 quad_perm:[3,3,3,3] row_mask:0xf bank_mask:0x5
    v_add_f32_dpp v42, v203, v42 quad_perm:[3,3,3,3] row_mask:0xf bank_mask:0x5
    v_add_f32_dpp v43, v207, v43 quad_perm:[3,3,3,3] row_mask:0xf bank_mask:0x5
    s_waitcnt lgkmcnt(0)
    v_readfirstlane_b32 s101, v31
    s_sub_u32 s98, s98, s100
    s_sub_u32 s3, s98, s101
    s_cmp_lt_i32 s3, 0
    s_cselect_b64 vcc, -1, 0
    s_add_u32 s100, s100, 58
    s_or_b32 s3, s98, 1
    v_mov_b32 v22, s3
    s_mov_b64 exec, s[62:63]
    ds_write_b32 v23, v22 offset:788
    s_mov_b64 exec, -1
    s_memrealtime s[98:99]
    ds_read_b32 v31, v0 offset:532
    s_waitcnt vmcnt(6)
    s_cbranch_vccz L_t71
    s_waitcnt vmcnt(4)
L_t71:
    s_xor_b32 s42, s41, 98304
    buffer_load_dwordx4 v[48:51], v2, s[12:15], s42 offen offset:0 nt
    s_waitcnt vmcnt(17)
    v_mfma_f32_16x16x32_bf16 v[224:227], v[224:227], v[8:11], 0
    v_mfma_f32_16x16x32_bf16 v[228:231], v[228:231], v[8:11], 0
    v_mfma_f32_16x16x32_bf16 v[232:235], v[232:235], v[8:11], 0
    v_mfma_f32_16x16x32_bf16 v[236:239], v[236:239], v[8:11], 0
    s_waitcnt vmcnt(6)
    s_cbranch_vccz L_t72
    s_waitcnt vmcnt(4)
L_t72:
    buffer_load_dwordx4 v[52:55], v2, s[12:15], s42 offen offset:1024 nt
    v_mov_b32_dpp v40, v208 quad_perm:[0,0,0,0] row_mask:0xf bank_mask:0xa
    v_mov_b32_dpp v41, v212 quad_perm:[0,0,0,0] row_mask:0xf bank_mask:0xa
    v_mov_b32_dpp v42, v216 quad_perm:[0,0,0,0] row_mask:0xf bank_mask:0xa
    v_mov_b32_dpp v43, v220 quad_perm:[0,0,0,0] row_mask:0xf bank_mask:0xa
    v_add_f32_dpp v40, v209, v40 quad_perm:[1,1,1,1] row_mask:0xf bank_mask:0xa
    v_add_f32_dpp v41, v213, v41 quad_perm:[1,1,1,1] row_mask:0xf bank_mask:0xa
    v_add_f32_dpp v42, v217, v42 quad_perm:[1,1,1,1] row_mask:0xf bank_mask:0xa
    v_add_f32_dpp v43, v221, v43 quad_perm:[1,1,1,1] row_mask:0xf bank_mask:0xa
    v_add_f32_dpp v40, v210, v40 quad_perm:[2,2,2,2] row_mask:0xf bank_mask:0xa
    v_add_f32_dpp v41, v214, v41 quad_perm:[2,2,2,2] row_mask:0xf bank_mask:0xa
    v_add_f32_dpp v42, v218, v42 quad_perm:[2,2,2,2] row_mask:0xf bank_mask:0xa
    v_add_f32_dpp v43, v222, v43 quad_perm:[2,2,2,2] row_mask:0xf bank_mask:0xa
    v_add_f32_dpp v40, v211, v40 quad_perm:[3,3,3,3] row_mask:0xf bank_mask:0xa
    v_add_f32_dpp v41, v215, v41 quad_perm:[3,3,3,3] row_mask:0xf bank_mask:0xa
    v_add_f32_dpp v42, v219, v42 quad_perm:[3,3,3,3] row_mask:0xf bank_mask:0xa
    v_add_f32_dpp v43, v223, v43 quad_perm:[3,3,3,3] row_mask:0xf bank_mask:0xa
    s_waitcnt vmcnt(6)
    s_cbranch_vccz L_t73
    s_waitcnt vmcnt(4)
L_t73:
    buffer_load_dwordx4 v[56:59], v2, s[12:15], s42 offen offset:2048 nt
    s_waitcnt vmcnt(15)
    v_mfma_f32_16x16x32_bf16 v[240:243], v[240:243], v[8:11], 0
    v_mfma_f32_16x16x32_bf16 v[244:247], v[244:247], v[8:11], 0
    v_mfma_f32_16x16x32_bf16 v[248:251], v[248:251], v[8:11], 0
    v_mfma_f32_16x16x32_bf16 v[252:255], v[252:255], v[8:11], 0
    s_waitcnt vmcnt(6)
    s_cbranch_vccz L_t74
    s_waitcnt vmcnt(4)
L_t74:
    buffer_load_dwordx4 v[60:63], v2, s[12:15], s42 offen offset:3072 nt
    v_mov_b32_dpp v44, v224 quad_perm:[0,0,0,0] row_mask:0xf bank_mask:0x5
    v_mov_b32_dpp v45, v228 quad_perm:[0,0,0,0] row_mask:0xf bank_mask:0x5
    v_mov_b32_dpp v46, v232 quad_perm:[0,0,0,0] row_mask:0xf bank_mask:0x5
    v_mov_b32_dpp v47, v236 quad_perm:[0,0,0,0] row_mask:0xf bank_mask:0x5
    v_add_f32_dpp v44, v225, v44 quad_perm:[1,1,1,1] row_mask:0xf bank_mask:0x5
    v_add_f32_dpp v45, v229, v45 quad_perm:[1,1,1,1] row_mask:0xf bank_mask:0x5
    v_add_f32_dpp v46, v233, v46 quad_perm:[1,1,1,1] row_mask:0xf bank_mask:0x5
    v_add_f32_dpp v47, v237, v47 quad_perm:[1,1,1,1] row_mask:0xf bank_mask:0x5
    v_add_f32_dpp v44, v226, v44 quad_perm:[2,2,2,2] row_mask:0xf bank_mask:0x5
    v_add_f32_dpp v45, v230, v45 quad_perm:[2,2,2,2] row_mask:0xf bank_mask:0x5
    v_add_f32_dpp v46, v234, v46 quad_perm:[2,2,2,2] row_mask:0xf bank_mask:0x5
    v_add_f32_dpp v47, v238, v47 quad_perm:[2,2,2,2] row_mask:0xf bank_mask:0x5
    v_add_f32_dpp v44, v227, v44 quad_perm:[3,3,3,3] row_mask:0xf bank_mask:0x5
    v_add_f32_dpp v45, v231, v45 quad_perm:[3,3,3,3] row_mask:0xf bank_mask:0x5
    v_add_f32_dpp v46, v235, v46 quad_perm:[3,3,3,3] row_mask:0xf bank_mask:0x5
    v_add_f32_dpp v47, v239, v47 quad_perm:[3,3,3,3] row_mask:0xf bank_mask:0x5
    s_waitcnt lgkmcnt(0)
    v_readfirstlane_b32 s101, v31
    s_sub_u32 s98, s98, s100
    s_sub_u32 s3, s98, s101
    s_cmp_lt_i32 s3, 0
    s_cselect_b64 vcc, -1, 0
    s_add_u32 s100, s100, 58
    s_memrealtime s[98:99]
    ds_read_b32 v31, v0 offset:532
    s_waitcnt vmcnt(6)
    s_cbranch_vccz L_t75
    s_waitcnt vmcnt(4)
L_t75:
    s_xor_b32 s42, s41, 131072
    buffer_load_dwordx4 v[64:67], v2, s[12:15], s42 offen offset:0 nt
    s_waitcnt vmcnt(6)
    s_cbranch_vccz L_t76
    s_waitcnt vmcnt(4)
L_t76:
    buffer_load_dwordx4 v[68:71], v2, s[12:15], s42 offen offset:1024 nt
    v_mov_b32_dpp v44, v240 quad_perm:[0,0,0,0] row_mask:0xf bank_mask:0xa
    v_mov_b32_dpp v45, v244 quad_perm:[0,0,0,0] row_mask:0xf bank_mask:0xa
    v_mov_b32_dpp v46, v248 quad_perm:[0,0,0,0] row_mask:0xf bank_mask:0xa
    v_mov_b32_dpp v47, v252 quad_perm:[0,0,0,0] row_mask:0xf bank_mask:0xa
    v_add_f32_dpp v44, v241, v44 quad_perm:[1,1,1,1] row_mask:0xf bank_mask:0xa
    v_add_f32_dpp v45, v245, v45 quad_perm:[1,1,1,1] row_mask:0xf bank_mask:0xa
    v_add_f32_dpp v46, v249, v46 quad_perm:[1,1,1,1] row_mask:0xf bank_mask:0xa
    v_add_f32_dpp v47, v253, v47 quad_perm:[1,1,1,1] row_mask:0xf bank_mask:0xa
    v_add_f32_dpp v44, v242, v44 quad_perm:[2,2,2,2] row_mask:0xf bank_mask:0xa
    v_add_f32_dpp v45, v246, v45 quad_perm:[2,2,2,2] row_mask:0xf bank_mask:0xa
    v_add_f32_dpp v46, v250, v46 quad_perm:[2,2,2,2] row_mask:0xf bank_mask:0xa
    v_add_f32_dpp v47, v254, v47 quad_perm:[2,2,2,2] row_mask:0xf bank_mask:0xa
    v_add_f32_dpp v44, v243, v44 quad_perm:[3,3,3,3] row_mask:0xf bank_mask:0xa
    v_add_f32_dpp v45, v247, v45 quad_perm:[3,3,3,3] row_mask:0xf bank_mask:0xa
    v_add_f32_dpp v46, v251, v46 quad_perm:[3,3,3,3] row_mask:0xf bank_mask:0xa
    v_add_f32_dpp v47, v255, v47 quad_perm:[3,3,3,3] row_mask:0xf bank_mask:0xa
    s_waitcnt vmcnt(6)
    ds_read_b128 v[128:131], v30 offset:0
    ds_read_b128 v[132:135], v30 offset:1024
    ds_read_b128 v[136:139], v30 offset:2048
    ds_read_b128 v[140:143], v30 offset:3072
    ds_read_b128 v[144:147], v30 offset:4096
    ds_read_b128 v[148:151], v30 offset:5120
    ds_read_b128 v[152:155], v30 offset:6144
    ds_read_b128 v[156:159], v30 offset:7168
    ds_read_b128 v[160:163], v30 offset:8192
    ds_read_b128 v[164:167], v30 offset:9216
    ds_read_b128 v[168:171], v30 offset:10240
    ds_read_b128 v[172:175], v30 offset:11264
    v_max3_f32 v3, v32, v33, v34
    v_max3_f32 v4, v35, v36, v37
    v_max3_f32 v5, v38, v39, v40
    v_max3_f32 v3, v3, v41, v42
    v_max3_f32 v4, v4, v43, v44
    v_max3_f32 v5, v5, v45, v46
    v_max3_f32 v3, v3, v4, v47
    v_max_f32 v28, v3, v5
    s_nop 1
    v_max_f32_dpp v28, v28, v28 row_half_mirror row_mask:0xf bank_mask:0xf
    v_mov_b32 v3, v28
    s_nop 1
    v_permlane16_swap_b32 v28, v3
    v_max_f32 v28, v28, v3
    v_mov_b32 v3, v28
    s_nop 1
    v_permlane32_swap_b32 v28, v3
    v_max_f32 v28, v28, v3
    v_mul_f32 v28, s46, v28
    v_fma_f32 v32, v32, s46, -v28
    v_fma_f32 v33, v33, s46, -v28
    v_fma_f32 v34, v34, s46, -v28
    v_fma_f32 v35, v35, s46, -v28
    v_fma_f32 v36, v36, s46, -v28
    v_fma_f32 v37, v37, s46, -v28
    v_fma_f32 v38, v38, s46, -v28
    v_fma_f32 v39, v39, s46, -v28
    v_fma_f32 v40, v40, s46, -v28
    v_fma_f32 v41, v41, s46, -v28
    v_fma_f32 v42, v42, s46, -v28
    v_fma_f32 v43, v43, s46, -v28
    v_fma_f32 v44, v44, s46, -v28
    v_fma_f32 v45, v45, s46, -v28
    v_fma_f32 v46, v46, s46, -v28
    v_fma_f32 v47, v47, s46, -v28
    v_exp_f32 v32, v32
    v_exp_f32 v33, v33
    v_exp_f32 v34, v34
    v_exp_f32 v35, v35
    v_exp_f32 v36, v36
    v_exp_f32 v37, v37
    v_exp_f32 v38, v38
    v_exp_f32 v39, v39
    v_exp_f32 v40, v40
    v_exp_f32 v41, v41
    v_exp_f32 v42, v42
    v_exp_f32 v43, v43
    v_exp_f32 v44, v44
    v_exp_f32 v45, v45
    v_exp_f32 v46, v46
    v_exp_f32 v47, v47
    v_add_f32 v29, v32, v33
    v_add_f32 v3, v34, v35
    v_add_f32 v29, v29, v36
    v_add_f32 v3, v3, v37
    v_add_f32 v29, v29, v38
    v_add_f32 v3, v3, v39
    v_add_f32 v29, v29, v40
    v_add_f32 v3, v3, v41
    v_add_f32 v29, v29, v42
    v_add_f32 v3, v3, v43
    v_add_f32 v29, v29, v44
    v_add_f32 v3, v3, v45
    v_add_f32 v29, v29, v46
    v_add_f32 v3, v3, v47
    v_add_f32 v29, v29, v3
    v_cvt_pk_bf16_f32 v32, v32, v32
    v_cvt_pk_bf16_f32 v33, v33, v33
    v_cvt_pk_bf16_f32 v34, v34, v34
    v_cvt_pk_bf16_f32 v35, v35, v35
    v_cvt_pk_bf16_f32 v36, v36, v36
    v_cvt_pk_bf16_f32 v37, v37, v37
    v_cvt_pk_bf16_f32 v38, v38, v38
    v_cvt_pk_bf16_f32 v39, v39, v39
    v_cvt_pk_bf16_f32 v40, v40, v40
    v_cvt_pk_bf16_f32 v41, v41, v41
    v_cvt_pk_bf16_f32 v42, v42, v42
    v_cvt_pk_bf16_f32 v43, v43, v43
    v_cvt_pk_bf16_f32 v44, v44, v44
    v_cvt_pk_bf16_f32 v45, v45, v45
    v_cvt_pk_bf16_f32 v46, v46, v46
    v_cvt_pk_bf16_f32 v47, v47, v47
    s_nop 1
    v_add_f32_dpp v29, v29, v29 row_half_mirror row_mask:0xf bank_mask:0xf
    v_mov_b32 v3, v29
    s_nop 1
    v_permlane16_swap_b32 v29, v3
    v_add_f32 v29, v29, v3
    v_mov_b32 v3, v29
    s_nop 1
    v_permlane32_swap_b32 v29, v3
    v_add_f32 v29, v29, v3
    v_lshlrev_b32 v4, 3, v7
    s_lshl_b32 s3, s36, 3
    v_add_u32 v4, s3, v4
    s_mov_b64 exec, 0x101
    ds_write_b64 v4, v[28:29] offset:576
    s_mov_b64 exec, 1
    v_mov_b32 v3, 1
    ds_add_u32 v0, v3 offset:520
    s_mov_b64 exec, -1
    s_waitcnt vmcnt(6)
    s_cbranch_vccz L_t77
    s_waitcnt vmcnt(4)
L_t77:
    buffer_load_dwordx4 v[72:75], v2, s[12:15], s42 offen offset:2048 nt
    s_waitcnt vmcnt(6)
    s_cbranch_vccz L_t78
    s_waitcnt vmcnt(4)
L_t78:
    buffer_load_dwordx4 v[76:79], v2, s[12:15], s42 offen offset:3072 nt
    s_waitcnt lgkmcnt(0)
    v_readfirstlane_b32 s101, v31
    s_sub_u32 s98, s98, s100
    s_sub_u32 s3, s98, s101
    s_cmp_lt_i32 s3, 0
    s_cselect_b64 vcc, -1, 0
    s_add_u32 s100, s100, 58
    s_or_b32 s3, s98, 1
    v_mov_b32 v22, s3
    s_mov_b64 exec, s[62:63]
    ds_write_b32 v23, v22 offset:792
    s_mov_b64 exec, -1
    s_memrealtime s[98:99]
    ds_read_b32 v31, v0 offset:532
    s_waitcnt vmcnt(6)
    s_cbranch_vccz L_t79
    s_waitcnt vmcnt(4)
L_t79:
    s_xor_b32 s42, s41, 196608
    buffer_load_dwordx4 v[80:83], v2, s[12:15], s42 offen offset:0 nt
    s_waitcnt vmcnt(6)
    s_cbranch_vccz L_t80
    s_waitcnt vmcnt(4)
L_t80:
    buffer_load_dwordx4 v[84:87], v2, s[12:15], s42 offen offset:1024 nt
    s_waitcnt vmcnt(6)
    s_cbranch_vccz L_t81
    s_waitcnt vmcnt(4)
L_t81:
    buffer_load_dwordx4 v[88:91], v2, s[12:15], s42 offen offset:2048 nt
    s_waitcnt vmcnt(6)
    s_cbranch_vccz L_t82
    s_waitcnt vmcnt(4)
L_t82:
    buffer_load_dwordx4 v[92:95], v2, s[12:15], s42 offen offset:3072 nt
    s_waitcnt lgkmcnt(0)
    v_readfirstlane_b32 s101, v31
    s_sub_u32 s98, s98, s100
    s_sub_u32 s3, s98, s101
    s_cmp_lt_i32 s3, 0
    s_cselect_b64 vcc, -1, 0
    s_add_u32 s100, s100, 58
    s_memrealtime s[98:99]
    ds_read_b32 v31, v0 offset:532
    s_waitcnt vmcnt(6)
    s_cbranch_vccz L_t83
    s_waitcnt vmcnt(4)
L_t83:
    s_xor_b32 s42, s41, 163840
    buffer_load_dwordx4 v[96:99], v2, s[12:15], s42 offen offset:0 nt
    s_waitcnt vmcnt(6)
    s_cbranch_vccz L_t84
    s_waitcnt vmcnt(4)
L_t84:
    buffer_load_dwordx4 v[100:103], v2, s[12:15], s42 offen offset:1024 nt
    s_waitcnt vmcnt(6)
    s_cbranch_vccz L_t85
    s_waitcnt vmcnt(4)
L_t85:
    buffer_load_dwordx4 v[104:107], v2, s[12:15], s42 offen offset:2048 nt
    s_waitcnt vmcnt(6)
    s_cbranch_vccz L_t86
    s_waitcnt vmcnt(4)
L_t86:
    buffer_load_dwordx4 v[108:111], v2, s[12:15], s42 offen offset:3072 nt
    s_waitcnt lgkmcnt(0)
    v_readfirstlane_b32 s101, v31
    s_sub_u32 s98, s98, s100
    s_sub_u32 s3, s98, s101
    s_cmp_lt_i32 s3, 0
    s_cselect_b64 vcc, -1, 0
    s_add_u32 s100, s100, 58
    s_or_b32 s3, s98, 1
    v_mov_b32 v22, s3
    s_mov_b64 exec, s[62:63]
    ds_write_b32 v23, v22 offset:796
    s_mov_b64 exec, -1
    s_memrealtime s[98:99]
    ds_read_b32 v31, v0 offset:532
    s_waitcnt vmcnt(6)
    s_cbranch_vccz L_t87
    s_waitcnt vmcnt(4)
L_t87:
    s_xor_b32 s42, s41, 229376
    buffer_load_dwordx4 v[112:115], v2, s[12:15], s42 offen offset:0 nt
    s_waitcnt vmcnt(6)
    s_cbranch_vccz L_t88
    s_waitcnt vmcnt(4)
L_t88:
    buffer_load_dwordx4 v[116:119], v2, s[12:15], s42 offen offset:1024 nt
    s_waitcnt vmcnt(6)
    s_cbranch_vccz L_t89
    s_waitcnt vmcnt(4)
L_t89:
    buffer_load_dwordx4 v[120:123], v2, s[12:15], s42 offen offset:2048 nt
    s_waitcnt vmcnt(6)
    s_cbranch_vccz L_t90
    s_waitcnt vmcnt(4)
L_t90:
    buffer_load_dwordx4 v[124:127], v2, s[12:15], s42 offen offset:3072 nt
    s_mov_b64 exec, 1
    v_mov_b32 v3, 1
    ds_add_u32 v0, v3 offset:516
    s_mov_b64 exec, -1
L_pv:
    v_lshrrev_b32 v6, 5, v7
    v_mul_u32_u24 v6, 512, v6
    v_and_b32 v4, 15, v7
    v_lshl_add_u32 v6, v4, 5, v6
    v_bfe_u32 v4, v7, 4, 1
    v_lshl_add_u32 v6, v4, 4, v6
    s_lshl_b32 s3, s36, 10
    v_add_u32 v6, s3, v6
    v_and_b32 v16, v32, v12
    v_and_b32 v17, v32, v13
    v_and_b32_dpp v18, v32, v14 row_shr:4 row_mask:0xf bank_mask:0xf bound_ctrl:0
    v_and_b32_dpp v19, v32, v15 row_shr:4 row_mask:0xf bank_mask:0xf bound_ctrl:0
    s_waitcnt lgkmcnt(0)
    v_and_b32 v20, v33, v12
    v_and_b32 v21, v33, v13
    v_and_b32_dpp v22, v33, v14 row_shr:4 row_mask:0xf bank_mask:0xf bound_ctrl:0
    v_and_b32_dpp v23, v33, v15 row_shr:4 row_mask:0xf bank_mask:0xf bound_ctrl:0
    v_mfma_f32_16x16x32_bf16 v[24:27], v[16:19], v[128:131], 0
    v_and_b32 v16, v34, v12
    v_and_b32 v17, v34, v13
    v_and_b32_dpp v18, v34, v14 row_shr:4 row_mask:0xf bank_mask:0xf bound_ctrl:0
    v_and_b32_dpp v19, v34, v15 row_shr:4 row_mask:0xf bank_mask:0xf bound_ctrl:0
    v_mfma_f32_16x16x32_bf16 v[24:27], v[20:23], v[132:135], v[24:27]
    v_and_b32 v20, v35, v12
    v_and_b32 v21, v35, v13
    v_and_b32_dpp v22, v35, v14 row_shr:4 row_mask:0xf bank_mask:0xf bound_ctrl:0
    v_and_b32_dpp v23, v35, v15 row_shr:4 row_mask:0xf bank_mask:0xf bound_ctrl:0
    v_mfma_f32_16x16x32_bf16 v[24:27], v[16:19], v[136:139], v[24:27]
    v_and_b32_dpp v16, v32, v12 row_shl:4 row_mask:0xf bank_mask:0xf bound_ctrl:0
    v_and_b32_dpp v17, v32, v13 row_shl:4 row_mask:0xf bank_mask:0xf bound_ctrl:0
    v_and_b32 v18, v32, v14
    v_and_b32 v19, v32, v15
    v_mfma_f32_16x16x32_bf16 v[24:27], v[20:23], v[140:143], v[24:27]
    v_and_b32_dpp v20, v33, v12 row_shl:4 row_mask:0xf bank_mask:0xf bound_ctrl:0
    v_and_b32_dpp v21, v33, v13 row_shl:4 row_mask:0xf bank_mask:0xf bound_ctrl:0
    v_and_b32 v22, v33, v14
    v_and_b32 v23, v33, v15
    v_mfma_f32_16x16x32_bf16 v[24:27], v[16:19], v[144:147], v[24:27]
    v_and_b32_dpp v16, v34, v12 row_shl:4 row_mask:0xf bank_mask:0xf bound_ctrl:0
    v_and_b32_dpp v17, v34, v13 row_shl:4 row_mask:0xf bank_mask:0xf bound_ctrl:0
    v_and_b32 v18, v34, v14
    v_and_b32 v19, v34, v15
    v_mfma_f32_16x16x32_bf16 v[24:27], v[20:23], v[148:151], v[24:27]
    v_and_b32_dpp v20, v35, v12 row_shl:4 row_mask:0xf bank_mask:0xf bound_ctrl:0
    v_and_b32_dpp v21, v35, v13 row_shl:4 row_mask:0xf bank_mask:0xf bound_ctrl:0
    v_and_b32 v22, v35, v14
    v_and_b32 v23, v35, v15
    v_mfma_f32_16x16x32_bf16 v[24:27], v[16:19], v[152:155], v[24:27]
    v_and_b32 v16, v36, v12
    v_and_b32 v17, v36, v13
    v_and_b32_dpp v18, v36, v14 row_shr:4 row_mask:0xf bank_mask:0xf bound_ctrl:0
    v_and_b32_dpp v19, v36, v15 row_shr:4 row_mask:0xf bank_mask:0xf bound_ctrl:0
    v_mfma_f32_16x16x32_bf16 v[24:27], v[20:23], v[156:159], v[24:27]
    v_and_b32 v20, v37, v12
    v_and_b32 v21, v37, v13
    v_and_b32_dpp v22, v37, v14 row_shr:4 row_mask:0xf bank_mask:0xf bound_ctrl:0
    v_and_b32_dpp v23, v37, v15 row_shr:4 row_mask:0xf bank_mask:0xf bound_ctrl:0
    v_mfma_f32_16x16x32_bf16 v[24:27], v[16:19], v[160:163], v[24:27]
    v_and_b32 v16, v38, v12
    v_and_b32 v17, v38, v13
    v_and_b32_dpp v18, v38, v14 row_shr:4 row_mask:0xf bank_mask:0xf bound_ctrl:0
    v_and_b32_dpp v19, v38, v15 row_shr:4 row_mask:0xf bank_mask:0xf bound_ctrl:0
    v_mfma_f32_16x16x32_bf16 v[24:27], v[20:23], v[164:167], v[24:27]
    v_and_b32 v20, v39, v12
    v_and_b32 v21, v39, v13
    v_and_b32_dpp v22, v39, v14 row_shr:4 row_mask:0xf bank_mask:0xf bound_ctrl:0
    v_and_b32_dpp v23, v39, v15 row_shr:4 row_mask:0xf bank_mask:0xf bound_ctrl:0
    v_mfma_f32_16x16x32_bf16 v[24:27], v[16:19], v[168:171], v[24:27]
    v_and_b32_dpp v16, v36, v12 row_shl:4 row_mask:0xf bank_mask:0xf bound_ctrl:0
    v_and_b32_dpp v17, v36, v13 row_shl:4 row_mask:0xf bank_mask:0xf bound_ctrl:0
    v_and_b32 v18, v36, v14
    v_and_b32 v19, v36, v15
    v_mfma_f32_16x16x32_bf16 v[24:27], v[20:23], v[172:175], v[24:27]
    v_and_b32_dpp v20, v37, v12 row_shl:4 row_mask:0xf bank_mask:0xf bound_ctrl:0
    v_and_b32_dpp v21, v37, v13 row_shl:4 row_mask:0xf bank_mask:0xf bound_ctrl:0
    v_and_b32 v22, v37, v14
    v_and_b32 v23, v37, v15
    s_waitcnt vmcnt(19)
    v_mfma_f32_16x16x32_bf16 v[24:27], v[16:19], v[48:51], v[24:27]
    v_and_b32_dpp v16, v38, v12 row_shl:4 row_mask:0xf bank_mask:0xf bound_ctrl:0
    v_and_b32_dpp v17, v38, v13 row_shl:4 row_mask:0xf bank_mask:0xf bound_ctrl:0
    v_and_b32 v18, v38, v14
    v_and_b32 v19, v38, v15
    s_waitcnt vmcnt(18)
    v_mfma_f32_16x16x32_bf16 v[24:27], v[20:23], v[52:55], v[24:27]
    v_and_b32_dpp v20, v39, v12 row_shl:4 row_mask:0xf bank_mask:0xf bound_ctrl:0
    v_and_b32_dpp v21, v39, v13 row_shl:4 row_mask:0xf bank_mask:0xf bound_ctrl:0
    v_and_b32 v22, v39, v14
    v_and_b32 v23, v39, v15
    s_waitcnt vmcnt(17)
    v_mfma_f32_16x16x32_bf16 v[24:27], v[16:19], v[56:59], v[24:27]
    v_and_b32 v16, v40, v12
    v_and_b32 v17, v40, v13
    v_and_b32_dpp v18, v40, v14 row_shr:4 row_mask:0xf bank_mask:0xf bound_ctrl:0
    v_and_b32_dpp v19, v40, v15 row_shr:4 row_mask:0xf bank_mask:0xf bound_ctrl:0
    s_waitcnt vmcnt(16)
    v_mfma_f32_16x16x32_bf16 v[24:27], v[20:23], v[60:63], v[24:27]
    v_and_b32 v20, v41, v12
    v_and_b32 v21, v41, v13
    v_and_b32_dpp v22, v41, v14 row_shr:4 row_mask:0xf bank_mask:0xf bound_ctrl:0
    v_and_b32_dpp v23, v41, v15 row_shr:4 row_mask:0xf bank_mask:0xf bound_ctrl:0
    s_waitcnt vmcnt(15)
    v_mfma_f32_16x16x32_bf16 v[24:27], v[16:19], v[64:67], v[24:27]
    v_and_b32 v16, v42, v12
    v_and_b32 v17, v42, v13
    v_and_b32_dpp v18, v42, v14 row_shr:4 row_mask:0xf bank_mask:0xf bound_ctrl:0
    v_and_b32_dpp v19, v42, v15 row_shr:4 row_mask:0xf bank_mask:0xf bound_ctrl:0
    s_waitcnt vmcnt(14)
    v_mfma_f32_16x16x32_bf16 v[24:27], v[20:23], v[68:71], v[24:27]
    v_and_b32 v20, v43, v12
    v_and_b32 v21, v43, v13
    v_and_b32_dpp v22, v43, v14 row_shr:4 row_mask:0xf bank_mask:0xf bound_ctrl:0
    v_and_b32_dpp v23, v43, v15 row_shr:4 row_mask:0xf bank_mask:0xf bound_ctrl:0
    s_waitcnt vmcnt(13)
    v_mfma_f32_16x16x32_bf16 v[24:27], v[16:19], v[72:75], v[24:27]
    v_and_b32_dpp v16, v40, v12 row_shl:4 row_mask:0xf bank_mask:0xf bound_ctrl:0
    v_and_b32_dpp v17, v40, v13 row_shl:4 row_mask:0xf bank_mask:0xf bound_ctrl:0
    v_and_b32 v18, v40, v14
    v_and_b32 v19, v40, v15
    s_waitcnt vmcnt(12)
    v_mfma_f32_16x16x32_bf16 v[24:27], v[20:23], v[76:79], v[24:27]
    v_and_b32_dpp v20, v41, v12 row_shl:4 row_mask:0xf bank_mask:0xf bound_ctrl:0
    v_and_b32_dpp v21, v41, v13 row_shl:4 row_mask:0xf bank_mask:0xf bound_ctrl:0
    v_and_b32 v22, v41, v14
    v_and_b32 v23, v41, v15
    s_waitcnt vmcnt(11)
    v_mfma_f32_16x16x32_bf16 v[24:27], v[16:19], v[80:83], v[24:27]
    v_and_b32_dpp v16, v42, v12 row_shl:4 row_mask:0xf bank_mask:0xf bound_ctrl:0
    v_and_b32_dpp v17, v42, v13 row_shl:4 row_mask:0xf bank_mask:0xf bound_ctrl:0
    v_and_b32 v18, v42, v14
    v_and_b32 v19, v42, v15
    s_waitcnt vmcnt(10)
    v_mfma_f32_16x16x32_bf16 v[24:27], v[20:23], v[84:87], v[24:27]
    v_and_b32_dpp v20, v43, v12 row_shl:4 row_mask:0xf bank_mask:0xf bound_ctrl:0
    v_and_b32_dpp v21, v43, v13 row_shl:4 row_mask:0xf bank_mask:0xf bound_ctrl:0
    v_and_b32 v22, v43, v14
    v_and_b32 v23, v43, v15
    s_waitcnt vmcnt(9)
    v_mfma_f32_16x16x32_bf16 v[24:27], v[16:19], v[88:91], v[24:27]
    v_and_b32 v16, v44, v12
    v_and_b32 v17, v44, v13
    v_and_b32_dpp v18, v44, v14 row_shr:4 row_mask:0xf bank_mask:0xf bound_ctrl:0
    v_and_b32_dpp v19, v44, v15 row_shr:4 row_mask:0xf bank_mask:0xf bound_ctrl:0
    s_waitcnt vmcnt(8)
    v_mfma_f32_16x16x32_bf16 v[24:27], v[20:23], v[92:95], v[24:27]
    v_and_b32 v20, v45, v12
    v_and_b32 v21, v45, v13
    v_and_b32_dpp v22, v45, v14 row_shr:4 row_mask:0xf bank_mask:0xf bound_ctrl:0
    v_and_b32_dpp v23, v45, v15 row_shr:4 row_mask:0xf bank_mask:0xf bound_ctrl:0
    s_waitcnt vmcnt(7)
    v_mfma_f32_16x16x32_bf16 v[24:27], v[16:19], v[96:99], v[24:27]
    v_and_b32 v16, v46, v12
    v_and_b32 v17, v46, v13
    v_and_b32_dpp v18, v46, v14 row_shr:4 row_mask:0xf bank_mask:0xf bound_ctrl:0
    v_and_b32_dpp v19, v46, v15 row_shr:4 row_mask:0xf bank_mask:0xf bound_ctrl:0
    s_waitcnt vmcnt(6)
    v_mfma_f32_16x16x32_bf16 v[24:27], v[20:23], v[100:103], v[24:27]
    v_and_b32 v20, v47, v12
    v_and_b32 v21, v47, v13
    v_and_b32_dpp v22, v47, v14 row_shr:4 row_mask:0xf bank_mask:0xf bound_ctrl:0
    v_and_b32_dpp v23, v47, v15 row_shr:4 row_mask:0xf bank_mask:0xf bound_ctrl:0
    s_waitcnt vmcnt(5)
    v_mfma_f32_16x16x32_bf16 v[24:27], v[16:19], v[104:107], v[24:27]
    v_and_b32_dpp v16, v44, v12 row_shl:4 row_mask:0xf bank_mask:0xf bound_ctrl:0
    v_and_b32_dpp v17, v44, v13 row_shl:4 row_mask:0xf bank_mask:0xf bound_ctrl:0
    v_and_b32 v18, v44, v14
    v_and_b32 v19, v44, v15
    s_waitcnt vmcnt(4)
    v_mfma_f32_16x16x32_bf16 v[24:27], v[20:23], v[108:111], v[24:27]
    v_and_b32_dpp v20, v45, v12 row_shl:4 row_mask:0xf bank_mask:0xf bound_ctrl:0
    v_and_b32_dpp v21, v45, v13 row_shl:4 row_mask:0xf bank_mask:0xf bound_ctrl:0
    v_and_b32 v22, v45, v14
    v_and_b32 v23, v45, v15
    s_waitcnt vmcnt(3)
    v_mfma_f32_16x16x32_bf16 v[24:27], v[16:19], v[112:115], v[24:27]
    v_and_b32_dpp v16, v46, v12 row_shl:4 row_mask:0xf bank_mask:0xf bound_ctrl:0
    v_and_b32_dpp v17, v46, v13 row_shl:4 row_mask:0xf bank_mask:0xf bound_ctrl:0
    v_and_b32 v18, v46, v14
    v_and_b32 v19, v46, v15
    s_waitcnt vmcnt(2)
    v_mfma_f32_16x16x32_bf16 v[24:27], v[20:23], v[116:119], v[24:27]
    v_and_b32_dpp v20, v47, v12 row_shl:4 row_mask:0xf bank_mask:0xf bound_ctrl:0
    v_and_b32_dpp v21, v47, v13 row_shl:4 row_mask:0xf bank_mask:0xf bound_ctrl:0
    v_and_b32 v22, v47, v14
    v_and_b32 v23, v47, v15
    s_waitcnt vmcnt(1)
    v_mfma_f32_16x16x32_bf16 v[24:27], v[16:19], v[120:123], v[24:27]
    s_waitcnt vmcnt(0)
    v_mfma_f32_16x16x32_bf16 v[24:27], v[20:23], v[124:127], v[24:27]
    s_cmp_eq_u32 s5, 0
    v_mov_b32 v3, 1
    s_nop 5
    ds_write_b128 v6, v[24:27] offset:1024
    s_cbranch_scc1 L_early
    s_mov_b64 exec, 1
    ds_add_u32 v0, v3 offset:524
    s_mov_b64 exec, -1
    s_cmp_eq_u32 s36, 6
    s_cbranch_scc0 L_end
    s_branch L_w67
L_early:
    s_mov_b64 exec, 1
    v_mov_b32 v3, 1
    ds_add_u32 v0, v3 offset:520
    s_mov_b64 exec, -1
    s_sub_u32 s49, s36, 2
    v_lshrrev_b32 v114, 5, v7
    v_mul_u32_u24 v114, 288, v114
    v_and_b32 v4, 15, v7
    v_lshl_add_u32 v114, v4, 5, v114
    v_bfe_u32 v4, v7, 4, 1
    v_lshl_add_u32 v114, v4, 4, v114
    s_lshl_b32 s3, s49, 10
    v_add_u32 v114, s3, v114
    v_and_b32 v3, 15, v7
    v_lshrrev_b32 v6, 4, v7
    v_mul_u32_u24 v115, 18432, v6
    v_lshl_add_u32 v115, v3, 4, v115
    v_cmp_lt_u32 vcc, 8, v3
    v_bfrev_b32 v3, 1
    v_bfe_u32 v112, v7, 3, 1
    v_cndmask_b32 v115, v115, v3, vcc
    v_and_b32 v4, 3, v7
    v_lshl_add_u32 v112, v112, 2, v4
    v_mul_u32_u24 v112, 1152, v112
    v_bfe_u32 v5, v7, 2, 1
    v_lshl_add_u32 v113, v6, 6, v112
    v_lshl_add_u32 v113, v5, 5, v113
    s_mov_b32 s6, 1
    s_branch L_proj
L_dryback:
    s_mov_b32 s6, 0
    s_mov_b64 exec, -1
    s_lshl_b32 s48, s38, 2
    s_add_u32 s48, s48, s49
    s_mul_i32 s48, s48, 73728
    s_mul_i32 s3, s39, 144
    s_add_u32 s48, s48, s3
    s_mul_i32 s46, s40, 9216
    s_add_u32 s46, s46, 0x90000
    s_lshl_b32 s51, s49, 8
    s_add_u32 s51, s51, s46
    s_cmp_eq_u32 s36, 5
    s_cbranch_scc0 L_noctl2
    v_lshlrev_b32 v37, 7, v7
    s_waitcnt lgkmcnt(0)
    s_add_u32 s4, s96, 0x9e3779b9
    v_mov_b32 v38, s4
    s_mov_b32 s49, 9
    s_mov_b32 s47, 8388608
    s_mov_b64 exec, 0xff
L_c2:
    s_lshl_b32 s3, s49, 2
    v_mov_b32 v36, s3
    ds_read_b32 v39, v36 offset:768
    ds_read_b32 v34, v0 offset:516
    s_waitcnt lgkmcnt(0)
    v_readfirstlane_b32 s3, v34
    v_readfirstlane_b32 s42, v39
    s_cmp_ge_u32 s3, 8
    s_cbranch_scc1 L_cd2
    s_cmp_lg_u32 s42, 0
    s_cbranch_scc1 L_cg2
    s_sub_u32 s47, s47, 1
    s_cbranch_scc1 L_end
    s_sleep 2
    s_branch L_c2
L_cg2:
    s_lshl_b32 s42, s49, 10
    s_add_u32 s42, s42, 0x8000
    s_cmp_lt_u32 s2, 8
    s_cbranch_scc0 L_cn2
    s_lshl_b32 s3, s2, 7
    s_add_u32 s3, s3, s42
    s_mov_b64 exec, 1
    buffer_store_dwordx2 v[38:39], v0, s[28:31], s3 offen sc1
    s_mov_b64 exec, 0xff
L_cn2:
    s_add_u32 s49, s49, 1
    s_cmp_le_u32 s49, 11
    s_cbranch_scc1 L_c2
    s_sub_u32 s42, s42, 2048
    buffer_load_dwordx2 v[32:33], v37, s[28:31], s42 offen sc1
    v_mov_b32 v34, 232
    s_waitcnt vmcnt(0)
    v_cmp_eq_u32 vcc, s4, v32
    v_sub_u32 v33, v33, v39
    s_nop 0
    v_cndmask_b32 v33, v34, v33, vcc
    s_nop 1
    v_add_u32_dpp v33, v33, v33 quad_perm:[1,0,3,2] row_mask:0xf bank_mask:0xf
    s_nop 1
    v_add_u32_dpp v33, v33, v33 quad_perm:[2,3,0,1] row_mask:0xf bank_mask:0xf
    s_nop 1
    v_add_u32_dpp v33, v33, v33 row_half_mirror row_mask:0xf bank_mask:0xf
    v_ashrrev_i32 v33, 3, v33
    v_add3_u32 v33, v33, v39, 0
    s_mov_b64 exec, 1
    ds_write_b32 v0, v33 offset:532
    s_mov_b64 exec, 0xff
    s_cmp_le_u32 s49, 13
    s_cbranch_scc1 L_c2
L_cd2:
    s_mov_b64 exec, -1
    s_mov_b32 s49, 3
L_noctl2:
    s_cmp_eq_u32 s36, 2
    s_cbranch_scc0 L_nostat
    v_lshrrev_b32 v5, 5, v7
    v_lshlrev_b32 v5, 6, v5
    v_lshrrev_b32 v4, 3, v5
    s_lshl_b32 s42, s40, 3
    s_add_u32 s42, s42, s39
    s_mul_i32 s42, s42, 1152
    s_add_u32 s42, s42, 0x90000
    s_and_b32 s3, s39, 3
    s_mul_i32 s3, s3, 1152
    s_sub_u32 s46, s42, s3
    v_and_b32 v30, 3, v7
    v_mul_u32_u24 v30, 1152, v30
    v_add_u32 v30, v30, v4
    ds_read_b32 v6, v0 offset:536
    s_mov_b32 s47, 8388608
L_wC:
    ds_read_b32 v3, v0 offset:520
    s_waitcnt lgkmcnt(0)
    v_readfirstlane_b32 s3, v3
    s_cmp_ge_u32 s3, 12
    s_cbranch_scc1 L_gC
    s_sub_u32 s47, s47, 1
    s_cbranch_scc1 L_end
    s_sleep 1
    s_branch L_wC
L_gC:
    v_readfirstlane_b32 s7, v6
    ds_read_b128 v[80:83], v5 offset:576
    ds_read_b128 v[84:87], v5 offset:592
    ds_read_b128 v[88:91], v5 offset:608
    ds_read_b128 v[92:95], v5 offset:624
    ds_read_b128 v[56:59], v2 offset:3072
    ds_read_b128 v[60:63], v2 offset:4096
    ds_read_b128 v[64:67], v2 offset:5120
    ds_read_b128 v[68:71], v2 offset:6144
    s_waitcnt lgkmcnt(4)
    v_max3_f32 v28, v80, v82, v84
    v_max3_f32 v28, v28, v86, v88
    v_max3_f32 v28, v28, v90, v92
    v_max_f32 v28, v28, v94
    v_sub_f32 v80, v80, v28
    v_sub_f32 v82, v82, v28
    v_sub_f32 v84, v84, v28
    v_sub_f32 v86, v86, v28
    v_sub_f32 v88, v88, v28
    v_sub_f32 v90, v90, v28
    v_sub_f32 v92, v92, v28
    v_sub_f32 v94, v94, v28
    v_exp_f32 v80, v80
    v_exp_f32 v82, v82
    v_exp_f32 v84, v84
    v_exp_f32 v86, v86
    v_exp_f32 v88, v88
    v_exp_f32 v90, v90
    v_exp_f32 v92, v92
    v_exp_f32 v94, v94
    v_mul_f32 v29, v80, v81
    v_fmac_f32 v29, v82, v83
    v_fmac_f32 v29, v84, v85
    v_fmac_f32 v29, v86, v87
    v_fmac_f32 v29, v88, v89
    v_fmac_f32 v29, v90, v91
    v_fmac_f32 v29, v92, v93
    v_fmac_f32 v29, v94, v95
    v_min_u32 v28, -2, v28
    v_min_u32 v29, -2, v29
    s_cmp_eq_u32 s7, 1
    s_cbranch_scc1 L_sl91
    s_mov_b32 exec_lo, 1
    s_mov_b32 exec_hi, 1
    buffer_store_dwordx2 v[28:29], v4, s[28:31], s42 offen offset:1024 sc1
    s_branch L_sd91
L_sl91:
    s_mov_b32 exec_lo, 1
    s_mov_b32 exec_hi, 1
    buffer_store_dwordx2 v[28:29], v4, s[28:31], s42 offen offset:1024
L_sd91:
    s_mov_b64 exec, -1
    s_mov_b32 s47, 2097152
    s_waitcnt vmcnt(0) lgkmcnt(0)
L_pollS:
    buffer_load_dwordx2 v[40:41], v30, s[28:31], s46 offen offset:1024 sc1
    s_waitcnt vmcnt(0)
    v_max_u32 v5, v40, v41
    v_cmp_eq_u32 vcc, -1, v5
    s_cbranch_vccz L_pollSdone
    s_sub_u32 s47, s47, 1
    s_cbranch_scc1 L_end
    s_sleep 4
    s_branch L_pollS
L_pollSdone:
    v_max_f32_dpp v5, v40, v40 quad_perm:[1,0,3,2] row_mask:0xf bank_mask:0xf
    s_nop 1
    v_max_f32_dpp v5, v5, v5 quad_perm:[2,3,0,1] row_mask:0xf bank_mask:0xf
    v_sub_f32 v6, v40, v5
    v_sub_f32 v5, v28, v5
    v_exp_f32 v6, v6
    v_exp_f32 v5, v5
    v_mul_f32 v6, v6, v41
    s_nop 1
    v_add_f32_dpp v6, v6, v6 quad_perm:[1,0,3,2] row_mask:0xf bank_mask:0xf
    s_nop 1
    v_add_f32_dpp v6, v6, v6 quad_perm:[2,3,0,1] row_mask:0xf bank_mask:0xf
    v_rcp_f32 v6, v6
    s_nop 0
    v_mul_f32 v5, v5, v6
    v_mul_f32 v80, v80, v5
    v_mul_f32 v82, v82, v5
    v_mul_f32 v84, v84, v5
    v_mul_f32 v86, v86, v5
    v_mul_f32 v88, v88, v5
    v_mul_f32 v90, v90, v5
    v_mul_f32 v92, v92, v5
    v_mul_f32 v94, v94, v5
    v_mul_f32 v24, v84, v56
    v_mul_f32 v25, v84, v57
    v_mul_f32 v26, v84, v58
    v_mul_f32 v27, v84, v59
    v_fmac_f32 v24, v86, v60
    v_fmac_f32 v25, v86, v61
    v_fmac_f32 v26, v86, v62
    v_fmac_f32 v27, v86, v63
    v_fmac_f32 v24, v88, v64
    v_fmac_f32 v25, v88, v65
    v_fmac_f32 v26, v88, v66
    v_fmac_f32 v27, v88, v67
    v_fmac_f32 v24, v90, v68
    v_fmac_f32 v25, v90, v69
    v_fmac_f32 v26, v90, v70
    v_fmac_f32 v27, v90, v71
L_nostat:
    s_mov_b32 s47, 8388608
L_wW:
    ds_read_b32 v3, v0 offset:516
    s_waitcnt lgkmcnt(0)
    v_readfirstlane_b32 s3, v3
    s_cmp_ge_u32 s3, 8
    s_cbranch_scc1 L_gW
    s_sub_u32 s47, s47, 1
    s_cbranch_scc1 L_end
    s_sleep 1
    s_branch L_wW
L_gW:
    buffer_load_dwordx4 v[176:179], v115, s[16:19], s48 offen offset:0 nt
    buffer_load_dwordx4 v[180:183], v115, s[16:19], s48 offen offset:1152 nt
    buffer_load_dwordx4 v[184:187], v115, s[16:19], s48 offen offset:2304 nt
    buffer_load_dwordx4 v[188:191], v115, s[16:19], s48 offen offset:3456 nt
    s_add_u32 s48, s48, 4608
    buffer_load_dwordx4 v[192:195], v115, s[16:19], s48 offen offset:0 nt
    buffer_load_dwordx4 v[196:199], v115, s[16:19], s48 offen offset:1152 nt
    buffer_load_dwordx4 v[200:203], v115, s[16:19], s48 offen offset:2304 nt
    buffer_load_dwordx4 v[204:207], v115, s[16:19], s48 offen offset:3456 nt
    s_add_u32 s48, s48, 4608
    buffer_load_dwordx4 v[208:211], v115, s[16:19], s48 offen offset:0 nt
    buffer_load_dwordx4 v[212:215], v115, s[16:19], s48 offen offset:1152 nt
    s_cmp_eq_u32 s36, 2
    s_cbranch_scc0 L_nocomb
    s_mov_b32 s47, 8388608
L_wD:
    ds_read_b32 v3, v0 offset:524
    s_waitcnt lgkmcnt(0)
    v_readfirstlane_b32 s3, v3
    s_cmp_ge_u32 s3, 4
    s_cbranch_scc1 L_gD
    s_sub_u32 s47, s47, 1
    s_cbranch_scc1 L_end
    s_branch L_wD
L_gD:
    ds_read_b128 v[72:75], v2 offset:7168
    ds_read_b128 v[76:79], v2 offset:8192
    ds_read_b128 v[48:51], v2 offset:1024
    ds_read_b128 v[52:55], v2 offset:2048
    s_waitcnt lgkmcnt(3)
    v_fmac_f32 v24, v92, v72
    v_fmac_f32 v25, v92, v73
    v_fmac_f32 v26, v92, v74
    v_fmac_f32 v27, v92, v75
    s_waitcnt lgkmcnt(2)
    v_fmac_f32 v24, v94, v76
    v_fmac_f32 v25, v94, v77
    v_fmac_f32 v26, v94, v78
    v_fmac_f32 v27, v94, v79
    s_waitcnt lgkmcnt(1)
    v_fmac_f32 v24, v80, v48
    v_fmac_f32 v25, v80, v49
    v_fmac_f32 v26, v80, v50
    v_fmac_f32 v27, v80, v51
    s_waitcnt lgkmcnt(0)
    v_fmac_f32 v24, v82, v52
    v_fmac_f32 v25, v82, v53
    v_fmac_f32 v26, v82, v54
    v_fmac_f32 v27, v82, v55
    v_min_u32 v24, -2, v24
    v_min_u32 v25, -2, v25
    v_min_u32 v26, -2, v26
    v_min_u32 v27, -2, v27
    s_cmp_eq_u32 s7, 1
    s_cbranch_scc1 L_sl92
    buffer_store_dwordx4 v[24:27], v2, s[28:31], s42 offen sc1
    s_branch L_sd92
L_sl92:
    buffer_store_dwordx4 v[24:27], v2, s[28:31], s42 offen
L_sd92:
    s_mov_b64 exec, 1
    v_mov_b32 v3, 1
    ds_add_u32 v0, v3 offset:528
    s_mov_b64 exec, -1
    s_branch L_gW2
L_nocomb:
    s_mov_b32 s47, 8388608
L_wW2:
    ds_read_b32 v3, v0 offset:528
    s_waitcnt lgkmcnt(0)
    v_readfirstlane_b32 s3, v3
    s_cmp_ge_u32 s3, 1
    s_cbranch_scc1 L_gW2
    s_sub_u32 s47, s47, 1
    s_cbranch_scc1 L_end
    s_sleep 1
    s_branch L_wW2
L_gW2:
    s_mov_b32 s47, 2097152
    buffer_load_dwordx4 v[216:219], v115, s[16:19], s48 offen offset:2304 nt
    buffer_load_dwordx4 v[220:223], v115, s[16:19], s48 offen offset:3456 nt
    s_waitcnt vmcnt(6)
    buffer_load_dwordx4 v[32:35], v113, s[28:31], s51 offen sc1
    buffer_load_dwordx4 v[36:39], v113, s[28:31], s51 offen offset:16 sc1
    s_add_u32 s48, s48, 4608
    buffer_load_dwordx4 v[224:227], v115, s[16:19], s48 offen offset:0 nt
    buffer_load_dwordx4 v[228:231], v115, s[16:19], s48 offen offset:1152 nt
    buffer_load_dwordx4 v[232:235], v115, s[16:19], s48 offen offset:2304 nt
    buffer_load_dwordx4 v[236:239], v115, s[16:19], s48 offen offset:3456 nt
    s_waitcnt vmcnt(4)
    s_branch L_chk1
L_poll1:
    buffer_load_dwordx4 v[32:35], v113, s[28:31], s51 offen sc1
    buffer_load_dwordx4 v[36:39], v113, s[28:31], s51 offen offset:16 sc1
    s_waitcnt vmcnt(0)
L_chk1:
    v_max3_u32 v5, v32, v33, v34
    v_max3_u32 v6, v35, v36, v37
    v_max3_u32 v5, v5, v38, v39
    v_max_u32 v5, v5, v6
    v_cmp_eq_u32 vcc, -1, v5
    s_cbranch_vccz L_poll1done
    s_sub_u32 s47, s47, 1
    s_cbranch_scc1 L_end
    s_sleep 1
    s_branch L_poll1
L_poll1done:
L_proj:
    v_add_f32_dpp v32, v32, v32 quad_perm:[1,0,3,2] row_mask:0xf bank_mask:0xf
    v_add_f32_dpp v33, v33, v33 quad_perm:[1,0,3,2] row_mask:0xf bank_mask:0xf
    v_add_f32_dpp v34, v34, v34 quad_perm:[1,0,3,2] row_mask:0xf bank_mask:0xf
    v_add_f32_dpp v35, v35, v35 quad_perm:[1,0,3,2] row_mask:0xf bank_mask:0xf
    v_add_f32_dpp v36, v36, v36 quad_perm:[1,0,3,2] row_mask:0xf bank_mask:0xf
    v_add_f32_dpp v37, v37, v37 quad_perm:[1,0,3,2] row_mask:0xf bank_mask:0xf
    v_add_f32_dpp v38, v38, v38 quad_perm:[1,0,3,2] row_mask:0xf bank_mask:0xf
    v_add_f32_dpp v39, v39, v39 quad_perm:[1,0,3,2] row_mask:0xf bank_mask:0xf
    v_add_f32_dpp v32, v32, v32 quad_perm:[2,3,0,1] row_mask:0xf bank_mask:0xf
    v_add_f32_dpp v33, v33, v33 quad_perm:[2,3,0,1] row_mask:0xf bank_mask:0xf
    v_add_f32_dpp v34, v34, v34 quad_perm:[2,3,0,1] row_mask:0xf bank_mask:0xf
    v_add_f32_dpp v35, v35, v35 quad_perm:[2,3,0,1] row_mask:0xf bank_mask:0xf
    v_add_f32_dpp v36, v36, v36 quad_perm:[2,3,0,1] row_mask:0xf bank_mask:0xf
    v_add_f32_dpp v37, v37, v37 quad_perm:[2,3,0,1] row_mask:0xf bank_mask:0xf
    v_add_f32_dpp v38, v38, v38 quad_perm:[2,3,0,1] row_mask:0xf bank_mask:0xf
    v_add_f32_dpp v39, v39, v39 quad_perm:[2,3,0,1] row_mask:0xf bank_mask:0xf
    v_cvt_pk_bf16_f32 v32, v32, v32
    v_cvt_pk_bf16_f32 v33, v33, v33
    v_cvt_pk_bf16_f32 v34, v34, v34
    v_cvt_pk_bf16_f32 v35, v35, v35
    v_cvt_pk_bf16_f32 v36, v36, v36
    v_cvt_pk_bf16_f32 v37, v37, v37
    v_cvt_pk_bf16_f32 v38, v38, v38
    v_cvt_pk_bf16_f32 v39, v39, v39
    v_and_b32 v16, v32, v12
    v_and_b32 v17, v32, v13
    v_and_b32_dpp v18, v32, v14 row_shr:4 row_mask:0xf bank_mask:0xf bound_ctrl:0
    v_and_b32_dpp v19, v32, v15 row_shr:4 row_mask:0xf bank_mask:0xf bound_ctrl:0
    v_and_b32 v20, v33, v12
    v_and_b32 v21, v33, v13
    v_and_b32_dpp v22, v33, v14 row_shr:4 row_mask:0xf bank_mask:0xf bound_ctrl:0
    v_and_b32_dpp v23, v33, v15 row_shr:4 row_mask:0xf bank_mask:0xf bound_ctrl:0
    v_mfma_f32_16x16x32_bf16 v[24:27], v[16:19], v[176:179], 0
    v_and_b32 v16, v34, v12
    v_and_b32 v17, v34, v13
    v_and_b32_dpp v18, v34, v14 row_shr:4 row_mask:0xf bank_mask:0xf bound_ctrl:0
    v_and_b32_dpp v19, v34, v15 row_shr:4 row_mask:0xf bank_mask:0xf bound_ctrl:0
    v_mfma_f32_16x16x32_bf16 v[24:27], v[20:23], v[180:183], v[24:27]
    v_and_b32 v20, v35, v12
    v_and_b32 v21, v35, v13
    v_and_b32_dpp v22, v35, v14 row_shr:4 row_mask:0xf bank_mask:0xf bound_ctrl:0
    v_and_b32_dpp v23, v35, v15 row_shr:4 row_mask:0xf bank_mask:0xf bound_ctrl:0
    v_mfma_f32_16x16x32_bf16 v[24:27], v[16:19], v[184:187], v[24:27]
    v_and_b32 v16, v36, v12
    v_and_b32 v17, v36, v13
    v_and_b32_dpp v18, v36, v14 row_shr:4 row_mask:0xf bank_mask:0xf bound_ctrl:0
    v_and_b32_dpp v19, v36, v15 row_shr:4 row_mask:0xf bank_mask:0xf bound_ctrl:0
    v_mfma_f32_16x16x32_bf16 v[24:27], v[20:23], v[188:191], v[24:27]
    v_and_b32 v20, v37, v12
    v_and_b32 v21, v37, v13
    v_and_b32_dpp v22, v37, v14 row_shr:4 row_mask:0xf bank_mask:0xf bound_ctrl:0
    v_and_b32_dpp v23, v37, v15 row_shr:4 row_mask:0xf bank_mask:0xf bound_ctrl:0
    v_mfma_f32_16x16x32_bf16 v[24:27], v[16:19], v[192:195], v[24:27]
    v_and_b32 v16, v38, v12
    v_and_b32 v17, v38, v13
    v_and_b32_dpp v18, v38, v14 row_shr:4 row_mask:0xf bank_mask:0xf bound_ctrl:0
    v_and_b32_dpp v19, v38, v15 row_shr:4 row_mask:0xf bank_mask:0xf bound_ctrl:0
    v_mfma_f32_16x16x32_bf16 v[24:27], v[20:23], v[196:199], v[24:27]
    v_and_b32 v20, v39, v12
    v_and_b32 v21, v39, v13
    v_and_b32_dpp v22, v39, v14 row_shr:4 row_mask:0xf bank_mask:0xf bound_ctrl:0
    v_and_b32_dpp v23, v39, v15 row_shr:4 row_mask:0xf bank_mask:0xf bound_ctrl:0
    v_mfma_f32_16x16x32_bf16 v[24:27], v[16:19], v[200:203], v[24:27]
    v_and_b32_dpp v16, v32, v12 row_shl:4 row_mask:0xf bank_mask:0xf bound_ctrl:0
    v_and_b32_dpp v17, v32, v13 row_shl:4 row_mask:0xf bank_mask:0xf bound_ctrl:0
    v_and_b32 v18, v32, v14
    v_and_b32 v19, v32, v15
    v_mfma_f32_16x16x32_bf16 v[24:27], v[20:23], v[204:207], v[24:27]
    v_and_b32_dpp v20, v33, v12 row_shl:4 row_mask:0xf bank_mask:0xf bound_ctrl:0
    v_and_b32_dpp v21, v33, v13 row_shl:4 row_mask:0xf bank_mask:0xf bound_ctrl:0
    v_and_b32 v22, v33, v14
    v_and_b32 v23, v33, v15
    v_mfma_f32_16x16x32_bf16 v[24:27], v[16:19], v[208:211], v[24:27]
    v_and_b32_dpp v16, v34, v12 row_shl:4 row_mask:0xf bank_mask:0xf bound_ctrl:0
    v_and_b32_dpp v17, v34, v13 row_shl:4 row_mask:0xf bank_mask:0xf bound_ctrl:0
    v_and_b32 v18, v34, v14
    v_and_b32 v19, v34, v15
    v_mfma_f32_16x16x32_bf16 v[24:27], v[20:23], v[212:215], v[24:27]
    v_and_b32_dpp v20, v35, v12 row_shl:4 row_mask:0xf bank_mask:0xf bound_ctrl:0
    v_and_b32_dpp v21, v35, v13 row_shl:4 row_mask:0xf bank_mask:0xf bound_ctrl:0
    v_and_b32 v22, v35, v14
    v_and_b32 v23, v35, v15
    v_mfma_f32_16x16x32_bf16 v[24:27], v[16:19], v[216:219], v[24:27]
    v_and_b32_dpp v16, v36, v12 row_shl:4 row_mask:0xf bank_mask:0xf bound_ctrl:0
    v_and_b32_dpp v17, v36, v13 row_shl:4 row_mask:0xf bank_mask:0xf bound_ctrl:0
    v_and_b32 v18, v36, v14
    v_and_b32 v19, v36, v15
    v_mfma_f32_16x16x32_bf16 v[24:27], v[20:23], v[220:223], v[24:27]
    v_and_b32_dpp v20, v37, v12 row_shl:4 row_mask:0xf bank_mask:0xf bound_ctrl:0
    v_and_b32_dpp v21, v37, v13 row_shl:4 row_mask:0xf bank_mask:0xf bound_ctrl:0
    v_and_b32 v22, v37, v14
    v_and_b32 v23, v37, v15
    s_waitcnt vmcnt(3)
    v_mfma_f32_16x16x32_bf16 v[24:27], v[16:19], v[224:227], v[24:27]
    v_and_b32_dpp v16, v38, v12 row_shl:4 row_mask:0xf bank_mask:0xf bound_ctrl:0
    v_and_b32_dpp v17, v38, v13 row_shl:4 row_mask:0xf bank_mask:0xf bound_ctrl:0
    v_and_b32 v18, v38, v14
    v_and_b32 v19, v38, v15
    s_waitcnt vmcnt(2)
    v_mfma_f32_16x16x32_bf16 v[24:27], v[20:23], v[228:231], v[24:27]
    v_and_b32_dpp v20, v39, v12 row_shl:4 row_mask:0xf bank_mask:0xf bound_ctrl:0
    v_and_b32_dpp v21, v39, v13 row_shl:4 row_mask:0xf bank_mask:0xf bound_ctrl:0
    v_and_b32 v22, v39, v14
    v_and_b32 v23, v39, v15
    s_waitcnt vmcnt(1)
    v_mfma_f32_16x16x32_bf16 v[24:27], v[16:19], v[232:235], v[24:27]
    s_waitcnt vmcnt(0)
    v_mfma_f32_16x16x32_bf16 v[24:27], v[20:23], v[236:239], v[24:27]
    s_mov_b32 exec_lo, 0x01ff01ff
    s_mov_b32 exec_hi, 0x01ff01ff
    s_nop 5
    ds_write_b128 v114, v[24:27] offset:9216
    s_cmp_eq_u32 s6, 1
    s_cbranch_scc1 L_dryback
    s_waitcnt lgkmcnt(0)
    s_barrier
    s_branch L_end
L_w67:
    s_lshl_b32 s42, s37, 3
    s_add_u32 s42, s42, s39
    s_mul_i32 s42, s42, 10240
    s_add_u32 s42, s42, 0xe0000
    s_mul_i32 s3, s38, 640
    s_add_u32 s51, s42, s3
    v_mov_b32 v17, s44
    v_mov_b32 v19, s44
    v_lshrrev_b32 v3, 2, v7
    v_mul_u32_u24 v3, 640, v3
    v_and_b32 v4, 3, v7
    v_lshl_add_u32 v3, v4, 4, v3
    s_lshl_b32 s3, s38, 6
    s_add_u32 s42, s42, s3
    s_lshl_b32 s3, s38, 2
    v_add_u32 v4, s3, v4
    v_cmp_lt_u32 vcc, 17, v4
    v_lshlrev_b32 v4, 3, v4
    v_add_u32 v5, 2160, v4
    s_mul_i32 s48, s37, 1152
    v_cndmask_b32 v4, v4, v5, vcc
    s_mul_i32 s3, s39, 144
    s_add_u32 s48, s48, s3
    s_mov_b32 s47, 2097152
    s_mov_b32 exec_hi, 0xf
    s_barrier
    ds_read_b128 v[32:35], v2 offset:9216
    ds_read_b128 v[36:39], v2 offset:10240
    ds_read_b128 v[40:43], v2 offset:11264
    ds_read_b128 v[44:47], v2 offset:12288
    s_waitcnt lgkmcnt(2)
    v_add_f32 v32, v32, v36
    v_add_f32 v33, v33, v37
    v_add_f32 v34, v34, v38
    v_add_f32 v35, v35, v39
    s_waitcnt lgkmcnt(0)
    v_add_f32 v40, v40, v44
    v_add_f32 v41, v41, v45
    v_add_f32 v42, v42, v46
    v_add_f32 v43, v43, v47
    v_add_f32 v32, v32, v40
    v_add_f32 v33, v33, v41
    v_add_f32 v34, v34, v42
    v_add_f32 v35, v35, v43
    v_cvt_pk_bf16_f32 v16, v32, v33
    v_cvt_pk_bf16_f32 v18, v34, v35
    buffer_store_dwordx4 v[16:19], v2, s[28:31], s51 offen sc1
    s_cmp_ge_u32 s38, 9
    s_cbranch_scc1 L_end
    s_mov_b32 exec_hi, -1
    s_waitcnt vmcnt(0)
    buffer_load_dwordx4 v[16:19], v3, s[28:31], s42 offen sc1
L_poll2:
    buffer_load_dwordx4 v[20:23], v3, s[28:31], s42 offen sc1
    s_waitcnt vmcnt(1)
    v_cmp_ne_u32 vcc, s44, v17
    v_cmp_ne_u32 s[52:53], s44, v19
    v_lshlrev_b32 v32, 16, v16
    v_and_b32 v33, 0xffff0000, v16
    v_lshlrev_b32 v34, 16, v18
    v_and_b32 v35, 0xffff0000, v18
    s_or_b64 vcc, vcc, s[52:53]
    s_cbranch_vccz L_poll2done
    buffer_load_dwordx4 v[16:19], v3, s[28:31], s42 offen sc1
    s_waitcnt vmcnt(1)
    v_cmp_ne_u32 vcc, s44, v21
    v_cmp_ne_u32 s[52:53], s44, v23
    v_lshlrev_b32 v32, 16, v20
    v_and_b32 v33, 0xffff0000, v20
    v_lshlrev_b32 v34, 16, v22
    v_and_b32 v35, 0xffff0000, v22
    s_or_b64 vcc, vcc, s[52:53]
    s_cbranch_vccz L_poll2done
    s_sub_u32 s47, s47, 1
    s_cbranch_scc1 L_end
    s_branch L_poll2
L_poll2done:
    v_add_f32_dpp v32, v32, v32 row_ror:4 row_mask:0xf bank_mask:0xf
    v_add_f32_dpp v33, v33, v33 row_ror:4 row_mask:0xf bank_mask:0xf
    v_add_f32_dpp v34, v34, v34 row_ror:4 row_mask:0xf bank_mask:0xf
    v_add_f32_dpp v35, v35, v35 row_ror:4 row_mask:0xf bank_mask:0xf
    v_add_f32_dpp v32, v32, v32 row_ror:8 row_mask:0xf bank_mask:0xf
    v_add_f32_dpp v33, v33, v33 row_ror:8 row_mask:0xf bank_mask:0xf
    v_add_f32_dpp v34, v34, v34 row_ror:8 row_mask:0xf bank_mask:0xf
    v_add_f32_dpp v35, v35, v35 row_ror:8 row_mask:0xf bank_mask:0xf
    v_mov_b32 v36, v32
    v_mov_b32 v37, v33
    v_mov_b32 v38, v34
    v_mov_b32 v39, v35
    v_permlane16_swap_b32 v32, v36
    v_permlane16_swap_b32 v33, v37
    v_permlane16_swap_b32 v34, v38
    v_permlane16_swap_b32 v35, v39
    v_add_f32 v32, v32, v36
    v_add_f32 v33, v33, v37
    v_add_f32 v34, v34, v38
    v_add_f32 v35, v35, v39
    v_mov_b32 v36, v32
    v_mov_b32 v37, v33
    v_mov_b32 v38, v34
    v_mov_b32 v39, v35
    v_permlane32_swap_b32 v32, v36
    v_permlane32_swap_b32 v33, v37
    v_permlane32_swap_b32 v34, v38
    v_permlane32_swap_b32 v35, v39
    v_add_f32 v32, v32, v36
    v_add_f32 v33, v33, v37
    v_add_f32 v34, v34, v38
    v_add_f32 v35, v35, v39
    s_mov_b64 exec, 15
    v_cvt_pk_bf16_f32 v36, v32, v33
    v_cvt_pk_bf16_f32 v37, v34, v35
    buffer_store_dwordx2 v[36:37], v4, s[32:35], s48 offen
    s_or_b32 s3, s38, s39
    s_cbranch_scc1 L_end
    s_mov_b64 exec, 1
    v_mov_b32 v3, s44
    s_lshl_b32 s3, s37, 8
    v_mov_b32 v4, s3
    buffer_store_dword v3, v4, s[28:31], 0 offen
    s_branch L_end
L_late1:
    s_load_dwordx2 s[28:29], s[0:1], 96
    s_load_dwordx2 s[12:13], s[0:1], s48 offset:16
    s_load_dwordx2 s[16:17], s[0:1], s48 offset:32
    s_load_dwordx2 s[32:33], s[0:1], 80
    s_mov_b32 s14, 0x2000000
    s_mov_b32 s15, 0x20000
    s_mov_b32 s30, 0x200000
    s_mov_b32 s31, 0x20000
    s_mov_b32 s18, 0x480000
    s_mov_b32 s19, 0x20000
    s_mov_b32 s34, 0x1200
    s_mov_b32 s35, 0x20000
    s_lshl_b32 s40, s37, 4
    s_add_u32 s40, s40, s38
    s_lshl_b32 s3, s37, 8
    s_waitcnt lgkmcnt(0)
    s_load_dword s43, s[28:29], s3
    s_load_dword s96, s[28:29], 0
    v_mov_b32 v0, 0
    v_and_b32 v3, 1, v7
    v_lshlrev_b32 v3, 4, v3
    v_mov_b32 v4, 0xffff
    v_lshlrev_b32 v3, v3, v4
    v_bfe_u32 v4, v7, 1, 2
    v_cmp_eq_u32 s[52:53], 0, v4
    v_cmp_eq_u32 s[54:55], 1, v4
    v_cmp_eq_u32 s[56:57], 2, v4
    v_cmp_eq_u32 s[58:59], 3, v4
    s_nop 1
    v_cndmask_b32 v12, 0, v3, s[52:53]
    v_cndmask_b32 v13, 0, v3, s[54:55]
    v_cndmask_b32 v14, 0, v3, s[56:57]
    v_cndmask_b32 v15, 0, v3, s[58:59]
    s_cmp_eq_u32 s36, 7
    s_cbranch_scc0 L_latewait
    v_lshlrev_b32 v37, 7, v7
    s_waitcnt lgkmcnt(0)
    s_add_u32 s4, s96, 0x9e3779b9
    v_mov_b32 v38, s4
    s_mov_b32 s49, 1
    s_mov_b32 s47, 8388608
    s_mov_b64 exec, 0xff
L_c1:
    s_lshl_b32 s3, s49, 2
    v_mov_b32 v36, s3
    ds_read_b32 v39, v36 offset:768
    ds_read_b32 v34, v0 offset:516
    s_waitcnt lgkmcnt(0)
    v_readfirstlane_b32 s3, v34
    v_readfirstlane_b32 s42, v39
    s_cmp_ge_u32 s3, 4
    s_cbranch_scc1 L_cd1
    s_cmp_lg_u32 s42, 0
    s_cbranch_scc1 L_cg1
    s_sub_u32 s47, s47, 1
    s_cbranch_scc1 L_end
    s_sleep 2
    s_branch L_c1
L_cg1:
    s_lshl_b32 s42, s49, 10
    s_add_u32 s42, s42, 0x8000
    s_cmp_lt_u32 s2, 8
    s_cbranch_scc0 L_cn1
    s_lshl_b32 s3, s2, 7
    s_add_u32 s3, s3, s42
    s_mov_b64 exec, 1
    buffer_store_dwordx2 v[38:39], v0, s[28:31], s3 offen sc1
    s_mov_b64 exec, 0xff
L_cn1:
    s_add_u32 s49, s49, 1
    s_cmp_le_u32 s49, 3
    s_cbranch_scc1 L_c1
    s_sub_u32 s42, s42, 2048
    buffer_load_dwordx2 v[32:33], v37, s[28:31], s42 offen sc1
    v_mov_b32 v34, 232
    s_waitcnt vmcnt(0)
    v_cmp_eq_u32 vcc, s4, v32
    v_sub_u32 v33, v33, v39
    s_nop 0
    v_cndmask_b32 v33, v34, v33, vcc
    s_nop 1
    v_add_u32_dpp v33, v33, v33 quad_perm:[1,0,3,2] row_mask:0xf bank_mask:0xf
    s_nop 1
    v_add_u32_dpp v33, v33, v33 quad_perm:[2,3,0,1] row_mask:0xf bank_mask:0xf
    s_nop 1
    v_add_u32_dpp v33, v33, v33 row_half_mirror row_mask:0xf bank_mask:0xf
    v_ashrrev_i32 v33, 3, v33
    v_add3_u32 v33, v33, v39, 0
    s_mov_b64 exec, 1
    ds_write_b32 v0, v33 offset:532
    s_mov_b64 exec, 0xff
    s_cmp_le_u32 s49, 6
    s_cbranch_scc1 L_c1
L_cd1:
    s_mov_b64 exec, -1
L_latewait:
    s_mov_b32 s47, 8388608
L_wK:
    ds_read_b32 v3, v0 offset:516
    s_waitcnt lgkmcnt(0)
    v_readfirstlane_b32 s3, v3
    s_cmp_ge_u32 s3, 4
    s_cbranch_scc1 L_gK
    s_sub_u32 s47, s47, 1
    s_cbranch_scc1 L_end
    s_sleep 1
    s_branch L_wK
L_gK:
    s_branch L_kgo
L_comm:
    s_load_dwordx2 s[28:29], s[0:1], 96
    s_load_dwordx2 s[12:13], s[0:1], s48 offset:16
    s_load_dwordx2 s[16:17], s[0:1], s48 offset:32
    s_load_dwordx2 s[32:33], s[0:1], 80
    s_mov_b32 s14, 0x2000000
    s_mov_b32 s15, 0x20000
    s_mov_b32 s30, 0x200000
    s_mov_b32 s31, 0x20000
    s_mov_b32 s18, 0x480000
    s_mov_b32 s19, 0x20000
    s_mov_b32 s34, 0x1200
    s_mov_b32 s35, 0x20000
    s_lshl_b32 s40, s37, 4
    s_add_u32 s40, s40, s38
    s_lshl_b32 s3, s37, 8
    s_waitcnt lgkmcnt(0)
    s_load_dword s43, s[28:29], s3
    s_load_dword s96, s[28:29], 0
    v_mov_b32 v0, 0
    v_and_b32 v3, 1, v7
    v_lshlrev_b32 v3, 4, v3
    v_mov_b32 v4, 0xffff
    v_lshlrev_b32 v3, v3, v4
    v_bfe_u32 v4, v7, 1, 2
    v_cmp_eq_u32 s[52:53], 0, v4
    v_cmp_eq_u32 s[54:55], 1, v4
    v_cmp_eq_u32 s[56:57], 2, v4
    v_cmp_eq_u32 s[58:59], 3, v4
    s_nop 1
    v_cndmask_b32 v12, 0, v3, s[52:53]
    v_cndmask_b32 v13, 0, v3, s[54:55]
    v_cndmask_b32 v14, 0, v3, s[56:57]
    v_cndmask_b32 v15, 0, v3, s[58:59]
    v_lshrrev_b32 v5, 4, v7
    v_bfe_u32 v31, v7, 3, 1
    v_mul_u32_u24 v31, 1152, v31
    v_mad_u32_u24 v31, v5, 2, v31
    s_mul_i32 s3, s39, 8
    s_add_u32 s3, s3, s49
    v_add_u32 v31, s3, v31
    s_getreg_b32 s7, hwreg(HW_REG_XCC_ID, 0, 4)
    s_lshl_b32 s48, s40, 3
    s_add_u32 s48, s48, s39
    s_lshl_b32 s4, s40, 7
    s_add_u32 s4, s4, 0x4000
    s_lshl_b32 s3, s39, 3
    v_mov_b32 v3, s3
    s_mov_b32 s50, 0x01000100
    s_waitcnt lgkmcnt(0)
    s_add_u32 s44, s43, 0x9e3779b9
    s_xor_b32 s45, s44, 0x5bd1e995
    s_and_b32 s45, s45, -16
    s_or_b32 s45, s45, s7
    v_mov_b32 v32, s44
    v_mov_b32 v33, s45
    s_mov_b64 exec, 1
    buffer_store_dwordx2 v[32:33], v3, s[28:31], s4 offen sc1
    s_mov_b64 exec, -1
    s_waitcnt vmcnt(1)
    ds_read_u16 v48, v31 offset:9216
    ds_read_u16 v49, v31 offset:9280
    ds_read_u16 v50, v31 offset:9344
    ds_read_u16 v51, v31 offset:9408
    ds_read_u16 v52, v31 offset:9472
    ds_read_u16 v53, v31 offset:9536
    ds_read_u16 v54, v31 offset:9600
    ds_read_u16 v55, v31 offset:9664
    ds_read_u16 v56, v31 offset:9728
    ds_read_u16 v57, v31 offset:9792
    ds_read_u16 v58, v31 offset:9856
    ds_read_u16 v59, v31 offset:9920
    ds_read_u16 v60, v31 offset:9984
    ds_read_u16 v61, v31 offset:10048
    ds_read_u16 v62, v31 offset:10112
    ds_read_u16 v63, v31 offset:10176
    ds_read_u16 v64, v31 offset:10240
    ds_read_u16 v65, v31 offset:10304
    s_waitcnt lgkmcnt(0)
    v_perm_b32 v3, v48, v48, s50
    v_and_b32 v16, v3, v12
    v_and_b32 v17, v3, v13
    v_and_b32 v18, v3, v14
    v_and_b32 v19, v3, v15
    v_perm_b32 v3, v49, v49, s50
    v_and_b32 v20, v3, v12
    v_and_b32 v21, v3, v13
    v_and_b32 v22, v3, v14
    v_and_b32 v23, v3, v15
    v_mfma_f32_16x16x32_bf16 v[24:27], v[16:19], v[128:131], 0
    v_perm_b32 v3, v50, v50, s50
    v_and_b32 v16, v3, v12
    v_and_b32 v17, v3, v13
    v_and_b32 v18, v3, v14
    v_and_b32 v19, v3, v15
    v_mfma_f32_16x16x32_bf16 v[24:27], v[20:23], v[132:135], v[24:27]
    v_perm_b32 v3, v51, v51, s50
    v_and_b32 v20, v3, v12
    v_and_b32 v21, v3, v13
    v_and_b32 v22, v3, v14
    v_and_b32 v23, v3, v15
    v_mfma_f32_16x16x32_bf16 v[24:27], v[16:19], v[136:139], v[24:27]
    v_perm_b32 v3, v52, v52, s50
    v_and_b32 v16, v3, v12
    v_and_b32 v17, v3, v13
    v_and_b32 v18, v3, v14
    v_and_b32 v19, v3, v15
    v_mfma_f32_16x16x32_bf16 v[24:27], v[20:23], v[140:143], v[24:27]
    v_perm_b32 v3, v53, v53, s50
    v_and_b32 v20, v3, v12
    v_and_b32 v21, v3, v13
    v_and_b32 v22, v3, v14
    v_and_b32 v23, v3, v15
    v_mfma_f32_16x16x32_bf16 v[24:27], v[16:19], v[144:147], v[24:27]
    v_perm_b32 v3, v54, v54, s50
    v_and_b32 v16, v3, v12
    v_and_b32 v17, v3, v13
    v_and_b32 v18, v3, v14
    v_and_b32 v19, v3, v15
    v_mfma_f32_16x16x32_bf16 v[24:27], v[20:23], v[148:151], v[24:27]
    v_perm_b32 v3, v55, v55, s50
    v_and_b32 v20, v3, v12
    v_and_b32 v21, v3, v13
    v_and_b32 v22, v3, v14
    v_and_b32 v23, v3, v15
    v_mfma_f32_16x16x32_bf16 v[24:27], v[16:19], v[152:155], v[24:27]
    v_perm_b32 v3, v56, v56, s50
    v_and_b32 v16, v3, v12
    v_and_b32 v17, v3, v13
    v_and_b32 v18, v3, v14
    v_and_b32 v19, v3, v15
    v_mfma_f32_16x16x32_bf16 v[24:27], v[20:23], v[156:159], v[24:27]
    v_perm_b32 v3, v57, v57, s50
    v_and_b32 v20, v3, v12
    v_and_b32 v21, v3, v13
    v_and_b32 v22, v3, v14
    v_and_b32 v23, v3, v15
    v_mfma_f32_16x16x32_bf16 v[24:27], v[16:19], v[160:163], v[24:27]
    v_perm_b32 v3, v58, v58, s50
    v_and_b32 v16, v3, v12
    v_and_b32 v17, v3, v13
    v_and_b32 v18, v3, v14
    v_and_b32 v19, v3, v15
    v_mfma_f32_16x16x32_bf16 v[24:27], v[20:23], v[164:167], v[24:27]
    v_perm_b32 v3, v59, v59, s50
    v_and_b32 v20, v3, v12
    v_and_b32 v21, v3, v13
    v_and_b32 v22, v3, v14
    v_and_b32 v23, v3, v15
    v_mfma_f32_16x16x32_bf16 v[24:27], v[16:19], v[168:171], v[24:27]
    v_perm_b32 v3, v60, v60, s50
    v_and_b32 v16, v3, v12
    v_and_b32 v17, v3, v13
    v_and_b32 v18, v3, v14
    v_and_b32 v19, v3, v15
    v_mfma_f32_16x16x32_bf16 v[24:27], v[20:23], v[172:175], v[24:27]
    v_perm_b32 v3, v61, v61, s50
    v_and_b32 v20, v3, v12
    v_and_b32 v21, v3, v13
    v_and_b32 v22, v3, v14
    v_and_b32 v23, v3, v15
    v_mfma_f32_16x16x32_bf16 v[24:27], v[16:19], v[176:179], v[24:27]
    v_perm_b32 v3, v62, v62, s50
    v_and_b32 v16, v3, v12
    v_and_b32 v17, v3, v13
    v_and_b32 v18, v3, v14
    v_and_b32 v19, v3, v15
    v_mfma_f32_16x16x32_bf16 v[24:27], v[20:23], v[180:183], v[24:27]
    v_perm_b32 v3, v63, v63, s50
    v_and_b32 v20, v3, v12
    v_and_b32 v21, v3, v13
    v_and_b32 v22, v3, v14
    v_and_b32 v23, v3, v15
    v_mfma_f32_16x16x32_bf16 v[24:27], v[16:19], v[184:187], v[24:27]
    v_perm_b32 v3, v64, v64, s50
    v_and_b32 v16, v3, v12
    v_and_b32 v17, v3, v13
    v_and_b32 v18, v3, v14
    v_and_b32 v19, v3, v15
    v_mfma_f32_16x16x32_bf16 v[24:27], v[20:23], v[188:191], v[24:27]
    v_perm_b32 v3, v65, v65, s50
    v_and_b32 v20, v3, v12
    v_and_b32 v21, v3, v13
    v_and_b32 v22, v3, v14
    v_and_b32 v23, v3, v15
    v_mfma_f32_16x16x32_bf16 v[24:27], v[16:19], v[192:195], v[24:27]
    s_nop 1
    v_mfma_f32_16x16x32_bf16 v[24:27], v[20:23], v[196:199], v[24:27]
    s_mov_b32 s47, 2097152
L_pollA:
    s_load_dwordx16 s[80:95], s[28:29], s4 glc
    s_waitcnt lgkmcnt(0)
    s_xor_b64 s[80:81], s[80:81], s[44:45]
    s_xor_b64 s[82:83], s[82:83], s[44:45]
    s_xor_b64 s[84:85], s[84:85], s[44:45]
    s_xor_b64 s[86:87], s[86:87], s[44:45]
    s_xor_b64 s[88:89], s[88:89], s[44:45]
    s_xor_b64 s[90:91], s[90:91], s[44:45]
    s_xor_b64 s[92:93], s[92:93], s[44:45]
    s_xor_b64 s[94:95], s[94:95], s[44:45]
    s_or_b64 s[80:81], s[80:81], s[82:83]
    s_or_b64 s[80:81], s[80:81], s[84:85]
    s_or_b64 s[80:81], s[80:81], s[86:87]
    s_or_b64 s[80:81], s[80:81], s[88:89]
    s_or_b64 s[80:81], s[80:81], s[90:91]
    s_or_b64 s[80:81], s[80:81], s[92:93]
    s_or_b64 s[80:81], s[80:81], s[94:95]
    s_cselect_b32 s7, 0, 1
    s_and_b32 s81, s81, -16
    s_or_b32 s80, s80, s81
    s_cbranch_scc0 L_pollAdone
    s_sub_u32 s47, s47, 1
    s_cbranch_scc1 L_end
    s_sleep 16
    s_branch L_pollA
L_pollAdone:
    s_and_b32 s45, s45, -16
    v_mov_b32 v32, -1
    v_mov_b32 v33, -1
    v_mov_b32 v34, -1
    v_mov_b32 v35, -1
    v_lshrrev_b32 v3, 5, v7
    v_mul_u32_u24 v3, 512, v3
    v_and_b32 v4, 15, v7
    v_lshl_add_u32 v3, v4, 5, v3
    v_bfe_u32 v4, v7, 4, 1
    v_lshl_add_u32 v3, v4, 4, v3
    s_lshl_b32 s42, s48, 1
    s_add_u32 s42, s42, s36
    s_lshl_b32 s42, s42, 10
    s_add_u32 s42, s42, 0x10000
    s_mul_i32 s51, s48, 1152
    s_lshl_b32 s3, s36, 10
    s_add_u32 s51, s51, s3
    s_add_u32 s51, s51, 0x90000
    s_cmp_eq_u32 s36, 0
    s_cselect_b64 s[52:53], -1, 1
    s_cmp_eq_u32 s7, 1
    s_cbranch_scc1 L_sl93
    buffer_store_dwordx4 v[24:27], v3, s[28:31], s42 offen sc1
    s_mov_b64 exec, s[52:53]
    buffer_store_dwordx4 v[32:35], v2, s[28:31], s51 offen sc1
    s_branch L_sd93
L_sl93:
    buffer_store_dwordx4 v[24:27], v3, s[28:31], s42 offen
    s_mov_b64 exec, s[52:53]
    buffer_store_dwordx4 v[32:35], v2, s[28:31], s51 offen
L_sd93:
    s_mov_b64 exec, -1
    v_mov_b32 v30, s44
    v_mov_b32 v31, s45
    s_lshl_b32 s42, s40, 1
    s_add_u32 s42, s42, s36
    s_lshl_b32 s42, s42, 7
    s_add_u32 s42, s42, 0x1000
    s_lshl_b32 s3, s39, 3
    v_mov_b32 v4, s3
    v_mov_b32 v6, s7
    s_waitcnt vmcnt(0)
    s_mov_b64 exec, 1
    buffer_store_dwordx2 v[30:31], v4, s[28:31], s42 offen sc1
    ds_write_b32 v0, v6 offset:536
    s_mov_b64 exec, -1
    s_mov_b32 s47, 2097152
    s_waitcnt vmcnt(0)
L_poll0:
    s_load_dwordx16 s[80:95], s[28:29], s42 glc
    s_waitcnt lgkmcnt(0)
    s_xor_b64 s[80:81], s[80:81], s[44:45]
    s_xor_b64 s[82:83], s[82:83], s[44:45]
    s_xor_b64 s[84:85], s[84:85], s[44:45]
    s_xor_b64 s[86:87], s[86:87], s[44:45]
    s_xor_b64 s[88:89], s[88:89], s[44:45]
    s_xor_b64 s[90:91], s[90:91], s[44:45]
    s_xor_b64 s[92:93], s[92:93], s[44:45]
    s_xor_b64 s[94:95], s[94:95], s[44:45]
    s_or_b64 s[80:81], s[80:81], s[82:83]
    s_or_b64 s[80:81], s[80:81], s[84:85]
    s_or_b64 s[80:81], s[80:81], s[86:87]
    s_or_b64 s[80:81], s[80:81], s[88:89]
    s_or_b64 s[80:81], s[80:81], s[90:91]
    s_or_b64 s[80:81], s[80:81], s[92:93]
    s_or_b64 s[80:81], s[80:81], s[94:95]
    s_cbranch_scc0 L_poll0done
    s_sub_u32 s47, s47, 1
    s_cbranch_scc1 L_end
    s_sleep 16
    s_branch L_poll0
L_poll0done:
    v_lshrrev_b32 v3, 5, v7
    v_lshlrev_b32 v3, 11, v3
    v_and_b32 v4, 31, v7
    v_lshl_add_u32 v3, v4, 4, v3
    s_lshl_b32 s42, s40, 14
    s_lshl_b32 s3, s36, 10
    s_add_u32 s42, s42, s3
    s_lshr_b32 s3, s39, 2
    s_lshl_b32 s3, s3, 9
    s_add_u32 s42, s42, s3
    s_add_u32 s42, s42, 0x10000
    buffer_load_dwordx4 v[32:35], v3, s[28:31], s42 offen sc1
    s_add_u32 s42, s42, 4096
    buffer_load_dwordx4 v[36:39], v3, s[28:31], s42 offen sc1
    s_add_u32 s42, s42, 4096
    buffer_load_dwordx4 v[40:43], v3, s[28:31], s42 offen sc1
    s_add_u32 s42, s42, 4096
    buffer_load_dwordx4 v[44:47], v3, s[28:31], s42 offen sc1
    v_lshlrev_b32 v31, 3, v4
    s_lshl_b32 s3, s36, 8
    v_add_u32 v31, s3, v31
    v_lshrrev_b32 v5, 4, v7
    s_sub_u32 s3, s36, 2
    s_bfe_u32 s5, s3, 0x10002
    s_and_b32 s3, s3, 3
    s_lshl_b32 s41, s3, 12
    s_lshl_b32 s3, s5, 14
    s_or_b32 s41, s41, s3
    s_lshl_b32 s3, s38, 20
    s_or_b32 s41, s41, s3
    s_and_b32 s3, s39, 3
    s_lshl_b32 s3, s3, 18
    s_or_b32 s41, s41, s3
    s_lshr_b32 s3, s39, 2
    s_lshl_b32 s3, s3, 24
    s_or_b32 s41, s41, s3
    s_mov_b32 s10, 0x2000000
    s_mov_b32 s11, 0x20000
    v_and_b32 v3, 3, v7
    v_bfe_u32 v4, v7, 2, 2
    v_lshlrev_b32 v1, 6, v5
    v_lshl_add_u32 v1, v3, 4, v1
    v_lshl_add_u32 v1, v4, 8, v1
    s_waitcnt vmcnt(0)
    v_add_f32 v32, v32, v36
    v_add_f32 v33, v33, v37
    v_add_f32 v34, v34, v38
    v_add_f32 v35, v35, v39
    v_add_f32 v40, v40, v44
    v_add_f32 v41, v41, v45
    v_add_f32 v42, v42, v46
    v_add_f32 v43, v43, v47
    v_add_f32 v32, v32, v40
    v_add_f32 v33, v33, v41
    v_add_f32 v34, v34, v42
    v_add_f32 v35, v35, v43
    v_mov_b32 v36, v32
    v_mov_b32 v37, v33
    v_mov_b32 v38, v34
    v_mov_b32 v39, v35
    s_nop 1
    v_permlane32_swap_b32 v32, v36
    v_permlane32_swap_b32 v33, v37
    v_permlane32_swap_b32 v34, v38
    v_permlane32_swap_b32 v35, v39
    v_add_f32 v32, v32, v36
    v_add_f32 v33, v33, v37
    v_add_f32 v34, v34, v38
    v_add_f32 v35, v35, v39
    v_cvt_pk_bf16_f32 v40, v32, v33
    v_cvt_pk_bf16_f32 v41, v34, v35
    ds_write_b64 v31, v[40:41] offset:0
    s_mov_b64 exec, 1
    v_mov_b32 v3, 1
    ds_add_u32 v0, v3 offset:512
    s_mov_b64 exec, -1
    s_branch L_latewait
L_end:
    s_endpgm
.section .rodata,"a"
.p2align 6
.amdhsa_kernel concat_heads__gqa_block_cached__gqa_block_cached__decode_kernel
  .amdhsa_next_free_vgpr 256
  .amdhsa_next_free_sgpr 102
  .amdhsa_accum_offset 256
  .amdhsa_group_segment_fixed_size 0
  .amdhsa_kernarg_size 104
  .amdhsa_user_sgpr_count 2
  .amdhsa_user_sgpr_kernarg_segment_ptr 1
  .amdhsa_system_sgpr_workgroup_id_x 1
.end_amdhsa_kernel
```
